```python
import torch

def _softmax(x, axis=-1):
    return torch.softmax(x, dim=axis)
def _gelu(x):
    return torch.nn.functional.gelu(x, approximate="tanh")
def _silu(x):
    return torch.nn.functional.silu(x)
def _sigmoid(x):
    return torch.sigmoid(x)
def _layernorm(x, axis=-1, eps=1e-5):
    m = x.mean(dim=axis, keepdim=True)
    v = x.var(dim=axis, keepdim=True, unbiased=False)
    return (x - m) / torch.sqrt(v + eps)
def _scatter_add(tgt, idx, src, axis=0):
    return tgt.clone().index_add_(axis, idx, src)
def _segment_sum(src, seg, n):
    out = torch.zeros((n,) + src.shape[1:], dtype=src.dtype)
    return out.index_add_(0, seg, src)
def _pad(x, pw):
    flat = tuple(v for pair in reversed(pw) for v in pair)
    return torch.nn.functional.pad(x, flat)

kernel_name = 'parallel_sum__compressed_kv_cla__glu_gated_swiglu__decode'

def setup_inputs():

    _w = (lambda a: (lambda t: t.to(torch.bfloat16) if t.is_floating_point() else t)(torch.as_tensor(a)))
    def _A_setup():
        B, H, Sq, Sk, D, M = 4, 32, 1, 4096, 128, 576
        Dc = 4 * D
        return {
            "x": _w((lambda *s: torch.randn(*s, dtype=torch.bfloat16) * 0.05)(B, Sq, M)),
            "c_kv": _w((lambda *s: torch.randn(*s, dtype=torch.bfloat16) * 0.8)(B, Sk, Dc)),
            "w_q": _w((lambda *s: torch.randn(*s, dtype=torch.bfloat16) * 1.6)(M, H, D) * (M ** -0.5)),
            "w_uk": _w((lambda *s: torch.randn(*s, dtype=torch.bfloat16) * 1.6)(Dc, H, D) * (Dc ** -0.5)),
            "w_uv": _w((lambda *s: torch.randn(*s, dtype=torch.bfloat16) * 0.8)(Dc, H, D) * (Dc ** -0.5)),
            "w_o": _w((lambda *s: torch.randn(*s, dtype=torch.bfloat16) * 0.8)(H, D, M) * ((H * D) ** -0.5)),
        }
    _A_in = _A_setup()

    def _B_setup():
        B, S, D, F = 4, 1, 576, 4608
        return {
            "x": _w((lambda *s: torch.randn(*s, dtype=torch.bfloat16) * 0.05)(B, S, D)),
            "w1": _w((lambda *s: torch.randn(*s, dtype=torch.bfloat16) * 0.4)(D, F) * (2.0 / D) ** 0.5),
            "w3": _w((lambda *s: torch.randn(*s, dtype=torch.bfloat16) * 0.4)(D, F) * (2.0 / D) ** 0.5),
            "w2": _w((lambda *s: torch.randn(*s, dtype=torch.bfloat16) * 0.4)(F, D) * (2.0 / F) ** 0.5),
        }
    _B_in = _B_setup()

    return {
        "A_x": _A_in["x"],
        "A_c_kv": _A_in["c_kv"],
        "A_w_q": _A_in["w_q"],
        "A_w_uk": _A_in["w_uk"],
        "A_w_uv": _A_in["w_uv"],
        "A_w_o": _A_in["w_o"],
        "B_x": _B_in["x"],
        "B_w1": _B_in["w1"],
        "B_w3": _B_in["w3"],
        "B_w2": _B_in["w2"],
    }

def reference(A_x, A_c_kv, A_w_q, A_w_uk, A_w_uv, A_w_o, B_x, B_w1, B_w3, B_w2):
    def _A_ref(x, c_kv, w_q, w_uk, w_uv, w_o):
        B, Sq, M = x.shape[0], x.shape[1], x.shape[2]
        Sk = c_kv.shape[1]
        H, D = w_q.shape[1], w_q.shape[2]
        q = torch.einsum("bqm,mhd->bhqd", x, w_q)
        k = torch.einsum("bkc,chd->bhkd", c_kv, w_uk)
        v = torch.einsum("bkc,chd->bhkd", c_kv, w_uv)
        scores = torch.einsum("bhqd,bhkd->bhqk", q, k) * (D ** -0.5)
        off = Sk - Sq
        qi = torch.arange(Sq)[:, None]
        kj = torch.arange(Sk)[None, :]
        cmask = kj <= (qi + off)
        scores = torch.where(cmask[None, None], scores, -1e9)
        p = _softmax(scores, axis=-1)
        ctx = torch.einsum("bhqk,bhkd->bhqd", p, v)
        return torch.einsum("bhqd,hdm->bqm", ctx, w_o)

    def _B_ref(x, w1, w3, w2):
        gate = torch.einsum("bsd,df->bsf", x, w1)
        up = torch.einsum("bsd,df->bsf", x, w3)
        h = _silu(gate) * up
        out = torch.einsum("bsf,fd->bsd", h, w2)
        return out

    x = A_x
    xn = _layernorm(x, axis=-1)
    return x + _A_ref(xn, A_c_kv, A_w_q, A_w_uk, A_w_uv, A_w_o) + _B_ref(xn, B_w1, B_w3, B_w2)
```

```asm
; @launch grid=(256,1,1) block=(256,1,1) lds=163840
.amdgcn_target "amdgcn-amd-amdhsa--gfx950"
.text
.globl parallel_sum__compressed_kv_cla__glu_gated_swiglu__decode_kernel
.p2align 8
.type parallel_sum__compressed_kv_cla__glu_gated_swiglu__decode_kernel,@function
parallel_sum__compressed_kv_cla__glu_gated_swiglu__decode_kernel:
    s_cmp_ge_u32 s2, 256
    s_cbranch_scc1 L_end
    s_load_dwordx2 s[36:37], s[0:1], 96
    s_mov_b32 s38, 8388608
    s_mov_b32 s39, 0x00020000
    s_load_dwordx2 s[40:41], s[0:1], 0
    s_mov_b32 s42, 4608
    s_mov_b32 s43, 0x00020000
    v_and_b32 v1, 63, v0
    v_lshrrev_b32 v2, 6, v0
    s_getpc_b64 s[60:61]
L_pc:
    v_lshlrev_b32 v3, 7, v0
    v_min_u32 v3, L_codeend-L_pc-4, v3
    v_readfirstlane_b32 s3, v2
    global_load_dword v255, v3, s[60:61]
    s_cmp_lt_u32 s2, 128
    s_cbranch_scc1 L_att
    s_load_dwordx2 s[44:45], s[0:1], 16
    s_mov_b32 s46, 4718592
    s_mov_b32 s47, 0x00020000
    s_load_dwordx2 s[52:53], s[0:1], 24
    s_mov_b32 s54, 4194304
    s_mov_b32 s55, 0x00020000
    s_and_b32 s8, s2, 7
    s_lshl_b32 s8, s8, 2
    s_bfe_u32 s6, s2, 0x20003
    s_or_b32 s8, s8, s6
    s_bfe_u32 s9, s2, 0x20005
    v_lshrrev_b32 v14, 4, v1
    v_and_b32 v15, 15, v1
    s_lshl_b32 s6, s3, 2
    v_add_u32 v5, s6, v14
    v_lshlrev_b32 v6, 4, v15
    v_lshl_add_u32 v4, v5, 16, v6
    v_lshl_add_u32 v7, v5, 13, v6
    s_mul_i32 s12, s9, 1179648
    s_lshl_b32 s6, s8, 8
    s_add_u32 s12, s12, s6
    v_bfe_u32 v6, v1, 3, 1
    v_mul_u32_u24 v6, 1152, v6
    v_lshl_add_u32 v208, v5, 4, v6
    v_lshl_add_u32 v209, v5, 1, v6
    s_mul_i32 s14, s9, 288
    s_lshl_b32 s16, s8, 2
    s_add_u32 s16, s16, s9
    s_lshl_b32 s16, s16, 2
    s_add_u32 s16, s16, s3
    s_and_b32 s27, s16, 15
    s_lshl_b32 s27, s27, 3
    s_lshl_b32 s6, s8, 11
    s_add_u32 s27, s27, s6
    s_add_u32 s27, s27, 458752
    s_lshl_b32 s16, s16, 6
    s_add_u32 s16, s16, 327680
    v_lshlrev_b32 v36, 15, v14
    v_lshl_add_u32 v36, v15, 2, v36
    v_mov_b32 v16, -1
    v_mov_b32 v17, -1
    v_mov_b32 v18, -1
    v_mov_b32 v19, -1
    s_waitcnt lgkmcnt(0)
    buffer_load_dwordx4 v[52:55], v208, s[40:43], s14 offen offset:0
    buffer_load_ushort v56, v209, s[40:43], s14 offen offset:256
    buffer_load_dwordx4 v[58:61], v208, s[40:43], s14 offen offset:2304
    buffer_load_ushort v62, v209, s[40:43], s14 offen offset:2560
    buffer_load_dwordx2 v[8:9], off, s[36:39], 0
    s_mul_i32 s6, s3, 1152
    v_lshlrev_b32 v2, 4, v1
    v_lshlrev_b32 v3, 1, v1
    buffer_load_dwordx4 v[156:159], v2, s[40:43], s6 offen
    buffer_load_ushort v160, v3, s[40:43], s6 offen offset:1024
    buffer_load_dwordx4 v[216:219], v4, s[44:47], s12 offen nt
    s_add_u32 s12, s12, 8192
    buffer_load_dwordx4 v[220:223], v4, s[44:47], s12 offen nt
    s_add_u32 s12, s12, 8192
    buffer_load_dwordx4 v[224:227], v4, s[44:47], s12 offen nt
    buffer_store_dword v16, v36, s[36:39], s16 offen sc1
    s_add_u32 s12, s12, 8192
    buffer_load_dwordx4 v[228:231], v4, s[44:47], s12 offen nt
    s_add_u32 s12, s12, 8192
    buffer_load_dwordx4 v[232:235], v4, s[44:47], s12 offen nt
    s_add_u32 s12, s12, 8192
    buffer_load_dwordx4 v[236:239], v4, s[44:47], s12 offen nt
    s_add_u32 s12, s12, 8192
    buffer_load_dwordx4 v[240:243], v4, s[44:47], s12 offen nt
    s_add_u32 s12, s12, 8192
    buffer_load_dwordx4 v[244:247], v4, s[44:47], s12 offen nt
    s_add_u32 s12, s12, 991232
    buffer_load_dwordx4 v[248:251], v7, s[44:47], s12 offen nt
    s_lshl_b32 s10, s9, 2
    s_add_u32 s10, s10, s3
    s_lshl_b32 s10, s10, 18
    s_lshl_b32 s6, s8, 8
    s_add_u32 s10, s10, s6
    v_lshrrev_b32 v6, 5, v1
    v_xor_b32 v6, v6, v15
    v_lshlrev_b32 v6, 4, v6
    v_lshl_add_u32 v37, v14, 13, v6
    s_lshl_b32 s11, s3, 13
    v_xor_b32 v38, 0, v37
    s_add_u32 m0, s11, 0
    s_add_u32 s6, s10, 0
    buffer_load_dwordx4 v38, s[52:55], s6 offen nt lds
    v_xor_b32 v38, 32, v37
    s_add_u32 m0, s11, 1024
    s_add_u32 s6, s10, 32768
    buffer_load_dwordx4 v38, s[52:55], s6 offen nt lds
    v_xor_b32 v38, 64, v37
    s_add_u32 m0, s11, 2048
    s_add_u32 s6, s10, 65536
    buffer_load_dwordx4 v38, s[52:55], s6 offen nt lds
    s_branch L_notatt2
L_att:
    s_load_dwordx2 s[48:49], s[0:1], 8
    s_mov_b32 s50, 16777216
    s_mov_b32 s51, 0x00020000
    s_load_dwordx2 s[52:53], s[0:1], 32
    s_mov_b32 s54, 4194304
    s_mov_b32 s55, 0x00020000
    v_lshrrev_b32 v14, 4, v1
    v_and_b32 v15, 15, v1
    s_bfe_u32 s10, s2, 0x20001
    s_lshr_b32 s11, s2, 3
    s_and_b32 s6, s2, 1
    s_lshl_b32 s6, s6, 4
    s_or_b32 s11, s11, s6
    v_lshlrev_b32 v6, 2, v14
    v_xor_b32 v6, v6, v15
    v_lshlrev_b32 v6, 4, v6
    v_lshl_add_u32 v212, v14, 10, v6
    v_xor_b32 v213, 32, v212
    v_xor_b32 v214, 16, v212
    v_xor_b32 v215, 48, v212
    s_lshl_b32 s13, s10, 22
    s_lshl_b32 s6, s11, 17
    s_add_u32 s13, s13, s6
    s_mul_i32 s6, s3, 0x8100
    s_add_u32 s13, s13, s6
    s_lshl_b32 s25, s3, 13
    v_lshlrev_b32 v203, 4, v1
    s_waitcnt lgkmcnt(0)
    buffer_load_dwordx2 v[8:9], off, s[36:39], 0
    s_add_u32 m0, s25, 0
    s_xor_b32 s6, s13, 0
    buffer_load_dwordx4 v212, s[48:51], s6 offen nt lds
    s_add_u32 m0, s25, 1024
    s_xor_b32 s6, s13, 4096
    buffer_load_dwordx4 v213, s[48:51], s6 offen nt lds
    s_lshl_b32 s26, s3, 14
    s_add_u32 s26, s26, 458752
    v_lshrrev_b32 v2, 3, v1
    v_and_b32 v3, 7, v1
    v_lshlrev_b32 v3, 4, v3
    v_lshl_add_u32 v216, v2, 11, v3
    s_and_b32 s8, s2, 7
    s_lshl_b32 s8, s8, 2
    s_bfe_u32 s6, s2, 0x20003
    s_or_b32 s8, s8, s6
    s_bfe_u32 s9, s2, 0x20005
    v_and_b32 v2, 1, v1
    v_lshlrev_b32 v2, 4, v2
    v_mov_b32 v3, 0xffff
    v_lshlrev_b32 v2, v2, v3
    v_bfe_u32 v3, v1, 1, 2
    v_cmp_eq_u32 vcc, 0, v3
    s_nop 1
    v_cndmask_b32 v10, 0, v2, vcc
    v_cmp_eq_u32 vcc, 1, v3
    s_nop 1
    v_cndmask_b32 v11, 0, v2, vcc
    v_cmp_eq_u32 vcc, 2, v3
    s_nop 1
    v_cndmask_b32 v12, 0, v2, vcc
    v_cmp_eq_u32 vcc, 3, v3
    s_nop 1
    v_cndmask_b32 v13, 0, v2, vcc
    v_and_b32 v2, 3, v1
    v_lshlrev_b32 v2, 2, v2
    v_bfe_u32 v3, v1, 2, 1
    v_lshl_or_b32 v2, v3, 1, v2
    v_bfe_u32 v3, v1, 3, 1
    v_or_b32 v2, v2, v3
    v_lshrrev_b32 v3, 5, v1
    v_xor_b32 v2, v2, v3
    v_lshlrev_b32 v2, 4, v2
    v_and_b32 v3, 31, v1
    v_lshl_add_u32 v2, v3, 8, v2
    v_add_u32 v176, s25, v2
    v_xor_b32 v177, 32, v176
    v_xor_b32 v178, 64, v176
    v_xor_b32 v179, 96, v176
    v_xor_b32 v180, 128, v176
    v_xor_b32 v181, 160, v176
    v_xor_b32 v182, 192, v176
    v_xor_b32 v183, 224, v176
    v_bfe_u32 v2, v1, 2, 2
    v_bfe_u32 v3, v1, 4, 1
    v_lshl_add_u32 v7, v3, 2, v2
    v_lshrrev_b32 v5, 5, v1
    v_lshl_add_u32 v7, v5, 4, v7
    v_lshlrev_b32 v2, 2, v2
    v_lshl_or_b32 v2, v3, 1, v2
    v_bfe_u32 v5, v1, 1, 1
    s_lshl_b32 s6, s3, 2
    v_or_b32 v3, s6, v5
    v_xor_b32 v2, v2, v3
    v_lshlrev_b32 v2, 4, v2
    v_lshl_add_u32 v2, v7, 8, v2
    v_and_b32 v3, 1, v1
    v_lshl_add_u32 v234, v3, 3, v2
    v_xor_b32 v235, 16, v234
    v_xor_b32 v236, 32, v234
    v_xor_b32 v237, 48, v234
    v_lshrrev_b32 v3, 5, v1
    v_xor_b32 v2, v3, v15
    v_lshlrev_b32 v2, 4, v2
    v_and_b32 v3, 31, v1
    v_lshl_add_u32 v2, v3, 10, v2
    s_lshl_b32 s6, s3, 8
    s_add_u32 s6, s6, 131072
    v_add_u32 v186, s6, v2
    v_xor_b32 v187, 32, v186
    v_xor_b32 v188, 64, v186
    v_xor_b32 v189, 96, v186
    v_xor_b32 v190, 128, v186
    v_xor_b32 v191, 160, v186
    v_xor_b32 v192, 192, v186
    v_xor_b32 v193, 224, v186
    s_and_b32 s6, s3, 1
    s_lshl_b32 s6, s6, 7
    v_xor_b32 v2, s6, v203
    s_add_u32 s6, s25, 131072
    v_add_u32 v194, s6, v2
    v_xor_b32 v195, 16, v194
    v_xor_b32 v196, 32, v194
    v_xor_b32 v197, 48, v194
    v_xor_b32 v198, 64, v194
    v_xor_b32 v199, 80, v194
    v_xor_b32 v200, 96, v194
    v_xor_b32 v201, 112, v194
    s_lshl_b32 s16, s10, 20
    s_lshl_b32 s6, s11, 15
    s_add_u32 s16, s16, s6
    s_add_u32 s16, s16, s25
    s_add_u32 s16, s16, 2097152
    s_add_u32 s29, s16, 4096
    s_lshl_b32 s17, s10, 15
    s_add_u32 s17, s17, s25
    s_add_u32 s17, s17, 327680
    s_add_u32 s28, s17, 4096
    s_and_b32 s6, s3, 1
    s_lshl_b32 s7, s6, 2
    v_or_b32 v2, s7, v14
    v_bfe_u32 v3, v1, 1, 3
    v_xor_b32 v2, v2, v3
    v_lshlrev_b32 v2, 5, v2
    v_lshl_add_u32 v2, v14, 20, v2
    v_and_b32 v3, 1, v1
    v_lshl_add_u32 v204, v3, 4, v2
    s_lshr_b32 s7, s3, 1
    s_lshl_b32 s19, s6, 1
    s_add_u32 s19, s19, s7
    s_lshl_b32 s19, s19, 10
    s_lshl_b32 s18, s7, 4
    s_add_u32 s18, s18, s6
    s_lshl_b32 s7, s9, 5
    s_add_u32 s18, s18, s7
    s_lshl_b32 s18, s18, 13
    s_lshl_b32 s6, s8, 8
    s_add_u32 s18, s18, s6
    v_and_b32 v2, 31, v1
    s_lshl_b32 s20, s10, 5
    s_add_u32 s20, s20, s11
    s_lshl_b32 s20, s20, 4
    s_lshl_b32 s6, s3, 11
    s_add_u32 s20, s20, s6
    v_lshlrev_b32 v219, 13, v2
    s_lshl_b32 s21, s8, 2
    s_add_u32 s21, s21, s9
    s_lshl_b32 s21, s21, 2
    s_add_u32 s21, s21, s3
    s_lshl_b32 s21, s21, 9
    v_lshlrev_b32 v218, 4, v2
    s_add_u32 s20, s20, 786432
    s_add_u32 s21, s21, 786432
    v_bfe_u32 v3, v1, 2, 2
    v_lshl_add_u32 v5, v14, 3, v3
    v_and_b32 v6, 1, v14
    v_lshl_or_b32 v3, v6, 2, v3
    s_lshl_b32 s6, s3, 1
    v_xor_b32 v3, s6, v3
    v_lshlrev_b32 v3, 5, v3
    v_lshl_add_u32 v5, v5, 8, v3
    v_and_b32 v3, 3, v1
    v_lshl_add_u32 v228, v3, 3, v5
    v_xor_b32 v229, 32, v228
    v_and_b32 v3, 3, v1
    v_lshlrev_b32 v3, 3, v3
    v_bfe_u32 v7, v1, 2, 3
    v_add_u32 v3, v3, v7
    s_lshl_b32 s6, s3, 7
    s_add_u32 s6, s6, 41984
    v_lshl_add_u32 v230, v3, 2, s6
    v_lshl_add_u32 v231, v14, 5, s6
    s_and_b32 s22, s8, 16
    s_and_b32 s6, s8, 3
    s_lshl_b32 s6, s6, 2
    s_or_b32 s22, s22, s6
    s_bfe_u32 s6, s8, 0x20002
    s_or_b32 s22, s22, s6
    s_lshl_b32 s22, s22, 8
    s_lshl_b32 s6, s9, 13
    s_add_u32 s22, s22, s6
    s_lshl_b32 s6, s3, 20
    s_add_u32 s22, s22, s6
    s_add_u32 s22, s22, 2097152
    v_lshlrev_b32 v202, 15, v14
    v_lshl_add_u32 v202, v15, 4, v202
    v_and_b32 v3, 1, v14
    v_lshlrev_b32 v3, 3, v3
    v_lshl_add_u32 v3, v15, 4, v3
    s_lshl_b32 s6, s3, 8
    s_add_u32 s6, s6, 42496
    v_add_u32 v205, s6, v3
    v_bfe_u32 v3, v1, 2, 2
    v_lshlrev_b32 v3, 8, v3
    v_lshl_add_u32 v3, v14, 4, v3
    v_add_u32 v206, 42496, v3
    s_lshl_b32 s24, s8, 2
    s_add_u32 s24, s24, s9
    s_lshl_b32 s24, s24, 11
    s_lshl_b32 s6, s3, 7
    s_add_u32 s24, s24, s6
    s_add_u32 s24, s24, 524288
    v_bfe_u32 v3, v1, 2, 2
    v_lshlrev_b32 v3, 9, v3
    v_lshl_add_u32 v3, v14, 4, v3
    v_and_b32 v232, 1, v1
    v_lshl_add_u32 v207, v232, 6, v3
    v_and_b32 v5, 31, v1
    v_lshlrev_b32 v5, 4, v5
    v_add_u32 v239, 32768, v5
    s_lshl_b32 s6, s3, 2
    v_add_u32 v238, s6, v239
    s_lshl_b32 s6, s3, 11
    s_add_u32 s6, s6, 33792
    v_add_u32 v240, s6, v203
    v_lshlrev_b32 v5, 9, v14
    v_lshl_add_u32 v5, v15, 4, v5
    v_add_u32 v241, 33792, v5
    s_waitcnt vmcnt(2)
    v_readfirstlane_b32 s4, v8
    v_readfirstlane_b32 s5, v9
    s_add_u32 s4, s4, 1
    s_addc_u32 s5, s5, 0
    s_getreg_b32 s6, hwreg(HW_REG_XCC_ID)
    v_mov_b32 v224, s6
    v_mov_b32 v225, s6
    v_mov_b32 v226, s4
    v_mov_b32 v227, s5
    s_lshl_b32 s6, s8, 2
    s_add_u32 s6, s6, s9
    s_lshl_b32 s6, s6, 6
    s_add_u32 s6, s6, 49152
    s_cmp_lg_u32 s3, 0
    s_cbranch_scc1 L_att_nohello
    s_mov_b64 exec, 1
    buffer_store_dwordx4 v[224:227], off, s[36:39], s6 sc1
    s_mov_b64 exec, -1
L_att_nohello:
    s_waitcnt vmcnt(1)
    s_add_u32 m0, s25, 2048
    s_xor_b32 s6, s13, 8192
    buffer_load_dwordx4 v214, s[48:51], s6 offen nt lds
    s_waitcnt vmcnt(1)
    s_add_u32 m0, s25, 3072
    s_xor_b32 s6, s13, 12288
    buffer_load_dwordx4 v215, s[48:51], s6 offen nt lds
    s_waitcnt vmcnt(1)
    s_add_u32 m0, s25, 4096
    s_xor_b32 s6, s13, 16384
    buffer_load_dwordx4 v212, s[48:51], s6 offen nt lds
    s_waitcnt vmcnt(1)
    s_add_u32 m0, s25, 5120
    s_xor_b32 s6, s13, 20480
    buffer_load_dwordx4 v213, s[48:51], s6 offen nt lds
    s_waitcnt vmcnt(1)
    s_add_u32 m0, s25, 6144
    s_xor_b32 s6, s13, 24576
    buffer_load_dwordx4 v214, s[48:51], s6 offen nt lds
    buffer_load_dword v254, v204, s[52:55], s18 offen
    s_add_u32 m0, s25, 7168
    s_xor_b32 s6, s13, 28672
    buffer_load_dwordx4 v215, s[48:51], s6 offen nt lds
    s_add_u32 m0, s25, 32768
    s_xor_b32 s6, s13, 256
    buffer_load_dwordx4 v212, s[48:51], s6 offen nt lds
    s_add_u32 m0, s25, 33792
    s_xor_b32 s6, s13, 4352
    buffer_load_dwordx4 v213, s[48:51], s6 offen nt lds
    s_add_u32 m0, s25, 34816
    s_xor_b32 s6, s13, 8448
    buffer_load_dwordx4 v214, s[48:51], s6 offen nt lds
    s_add_u32 m0, s25, 35840
    s_xor_b32 s6, s13, 12544
    buffer_load_dwordx4 v215, s[48:51], s6 offen nt lds
    s_waitcnt vmcnt(11)
    s_add_u32 m0, s25, 36864
    s_xor_b32 s6, s13, 16640
    buffer_load_dwordx4 v212, s[48:51], s6 offen nt lds
    s_waitcnt vmcnt(11)
    s_add_u32 m0, s25, 37888
    s_xor_b32 s6, s13, 20736
    buffer_load_dwordx4 v213, s[48:51], s6 offen nt lds
    s_waitcnt vmcnt(11)
    s_add_u32 m0, s25, 38912
    s_xor_b32 s6, s13, 24832
    buffer_load_dwordx4 v214, s[48:51], s6 offen nt lds
    s_waitcnt vmcnt(11)
    s_add_u32 m0, s25, 39936
    s_xor_b32 s6, s13, 28928
    buffer_load_dwordx4 v215, s[48:51], s6 offen nt lds
    s_waitcnt vmcnt(11)
    s_add_u32 m0, s25, 65536
    s_xor_b32 s6, s13, 512
    buffer_load_dwordx4 v212, s[48:51], s6 offen nt lds
    s_waitcnt vmcnt(11)
    s_add_u32 m0, s25, 66560
    s_xor_b32 s6, s13, 4608
    buffer_load_dwordx4 v213, s[48:51], s6 offen nt lds
    s_waitcnt vmcnt(11)
    s_add_u32 m0, s25, 67584
    s_xor_b32 s6, s13, 8704
    buffer_load_dwordx4 v214, s[48:51], s6 offen nt lds
    s_waitcnt vmcnt(11)
    s_add_u32 m0, s25, 68608
    s_xor_b32 s6, s13, 12800
    buffer_load_dwordx4 v215, s[48:51], s6 offen nt lds
    s_waitcnt vmcnt(12)
    ds_read_b128 a[0:3], v176 offset:0
    ds_read_b128 a[4:7], v177 offset:0
    ds_read_b128 a[8:11], v178 offset:0
    ds_read_b128 a[12:15], v179 offset:0
    s_waitcnt vmcnt(11)
    s_add_u32 m0, s25, 69632
    s_xor_b32 s6, s13, 16896
    buffer_load_dwordx4 v212, s[48:51], s6 offen nt lds
    buffer_load_dwordx4 v[220:223], v216, s[36:39], s26 offen
    ds_read_b128 a[16:19], v180 offset:0
    ds_read_b128 a[20:23], v181 offset:0
    ds_read_b128 a[24:27], v182 offset:0
    ds_read_b128 a[28:31], v183 offset:0
    s_waitcnt vmcnt(12)
    s_add_u32 m0, s25, 70656
    s_xor_b32 s6, s13, 20992
    buffer_load_dwordx4 v213, s[48:51], s6 offen nt lds
    s_barrier
    s_waitcnt vmcnt(12)
    s_add_u32 m0, s25, 71680
    s_xor_b32 s6, s13, 25088
    buffer_load_dwordx4 v214, s[48:51], s6 offen nt lds
    ds_read_b64_tr_b16 a[128:129], v234 offset:0
    ds_read_b64_tr_b16 a[130:131], v235 offset:2048
    ds_read_b64_tr_b16 a[144:145], v236 offset:0
    ds_read_b64_tr_b16 a[146:147], v237 offset:2048
    s_waitcnt vmcnt(12)
    s_add_u32 m0, s25, 72704
    s_xor_b32 s6, s13, 29184
    buffer_load_dwordx4 v215, s[48:51], s6 offen nt lds
    ds_read_b64_tr_b16 a[164:165], v234 offset:8192
    ds_read_b64_tr_b16 a[166:167], v235 offset:10240
    ds_read_b64_tr_b16 a[180:181], v236 offset:8192
    ds_read_b64_tr_b16 a[182:183], v237 offset:10240
    s_waitcnt vmcnt(12)
    s_add_u32 m0, s25, 98304
    s_xor_b32 s6, s13, 768
    buffer_load_dwordx4 v212, s[48:51], s6 offen nt lds
    ds_read_b64_tr_b16 a[200:201], v234 offset:16384
    ds_read_b64_tr_b16 a[202:203], v235 offset:18432
    ds_read_b64_tr_b16 a[216:217], v236 offset:16384
    ds_read_b64_tr_b16 a[218:219], v237 offset:18432
    s_waitcnt vmcnt(12)
    s_add_u32 m0, s25, 99328
    s_xor_b32 s6, s13, 4864
    buffer_load_dwordx4 v213, s[48:51], s6 offen nt lds
    ds_read_b64_tr_b16 a[236:237], v234 offset:24576
    ds_read_b64_tr_b16 a[238:239], v235 offset:26624
    ds_read_b64_tr_b16 a[252:253], v236 offset:24576
    ds_read_b64_tr_b16 a[254:255], v237 offset:26624
    s_waitcnt vmcnt(12)
    s_add_u32 m0, s25, 100352
    s_xor_b32 s6, s13, 8960
    buffer_load_dwordx4 v214, s[48:51], s6 offen nt lds
    s_waitcnt vmcnt(12)
    s_add_u32 m0, s25, 101376
    s_xor_b32 s6, s13, 13056
    buffer_load_dwordx4 v215, s[48:51], s6 offen nt lds
    s_waitcnt vmcnt(13)
    ds_read_b128 a[32:35], v176 offset:32768
    ds_read_b128 a[36:39], v177 offset:32768
    ds_read_b128 a[40:43], v178 offset:32768
    ds_read_b128 a[44:47], v179 offset:32768
    s_waitcnt vmcnt(12)
    s_add_u32 m0, s25, 102400
    s_xor_b32 s6, s13, 17152
    buffer_load_dwordx4 v212, s[48:51], s6 offen nt lds
    ds_read_b128 a[48:51], v180 offset:32768
    ds_read_b128 a[52:55], v181 offset:32768
    ds_read_b128 a[56:59], v182 offset:32768
    ds_read_b128 a[60:63], v183 offset:32768
    s_waitcnt vmcnt(12)
    s_add_u32 m0, s25, 103424
    s_xor_b32 s6, s13, 21248
    buffer_load_dwordx4 v213, s[48:51], s6 offen nt lds
    s_barrier
    s_waitcnt vmcnt(12)
    s_add_u32 m0, s25, 104448
    s_xor_b32 s6, s13, 25344
    buffer_load_dwordx4 v214, s[48:51], s6 offen nt lds
    ds_read_b64_tr_b16 a[160:161], v234 offset:32768
    ds_read_b64_tr_b16 a[162:163], v235 offset:34816
    ds_read_b64_tr_b16 a[176:177], v236 offset:32768
    ds_read_b64_tr_b16 a[178:179], v237 offset:34816
    s_waitcnt vmcnt(12)
    s_add_u32 m0, s25, 105472
    s_xor_b32 s6, s13, 29440
    buffer_load_dwordx4 v215, s[48:51], s6 offen nt lds
    ds_read_b64_tr_b16 a[132:133], v234 offset:40960
    ds_read_b64_tr_b16 a[134:135], v235 offset:43008
    ds_read_b64_tr_b16 a[148:149], v236 offset:40960
    ds_read_b64_tr_b16 a[150:151], v237 offset:43008
    s_waitcnt vmcnt(12)
    s_mov_b32 s63, 0
    s_waitcnt vmcnt(11)
L_na_poll_1:
    v_cmp_ne_u64 vcc, s[4:5], v[220:221]
    v_cmp_ne_u64 s[6:7], s[4:5], v[222:223]
    s_or_b64 vcc, vcc, s[6:7]
    s_cmp_eq_u64 vcc, 0
    s_cbranch_scc1 L_na_done_2
    buffer_load_dwordx4 v[220:223], v216, s[36:39], s26 offen sc1
    s_add_u32 s63, s63, 1
    s_cmp_lt_u32 s63, 20000
    s_waitcnt vmcnt(0)
    s_cbranch_scc1 L_na_poll_1
L_na_done_2:
    buffer_load_dwordx4 v[16:19], v203, s[36:39], s17 offen offset:0
    ds_read_b64_tr_b16 a[232:233], v234 offset:49152
    ds_read_b64_tr_b16 a[234:235], v235 offset:51200
    ds_read_b64_tr_b16 a[248:249], v236 offset:49152
    ds_read_b64_tr_b16 a[250:251], v237 offset:51200
    s_waitcnt vmcnt(11)
    buffer_load_dwordx4 v[20:23], v203, s[36:39], s17 offen offset:1024
    ds_read_b64_tr_b16 a[204:205], v234 offset:57344
    ds_read_b64_tr_b16 a[206:207], v235 offset:59392
    ds_read_b64_tr_b16 a[220:221], v236 offset:57344
    ds_read_b64_tr_b16 a[222:223], v237 offset:59392
    s_waitcnt vmcnt(11)
    buffer_load_dwordx4 v[24:27], v203, s[36:39], s17 offen offset:2048
    s_waitcnt vmcnt(11)
    buffer_load_dwordx4 v[28:31], v203, s[36:39], s17 offen offset:3072
    v_add_u32 v176, 0x10000, v176
    v_add_u32 v177, 0x10000, v177
    v_add_u32 v178, 0x10000, v178
    v_add_u32 v179, 0x10000, v179
    v_add_u32 v180, 0x10000, v180
    v_add_u32 v181, 0x10000, v181
    v_add_u32 v182, 0x10000, v182
    v_add_u32 v183, 0x10000, v183
    s_waitcnt vmcnt(12)
    ds_read_b128 a[64:67], v176 offset:0
    ds_read_b128 a[68:71], v177 offset:0
    ds_read_b128 a[72:75], v178 offset:0
    ds_read_b128 a[76:79], v179 offset:0
    s_waitcnt vmcnt(11)
    buffer_load_dwordx4 v[32:35], v203, s[36:39], s28 offen offset:0
    ds_read_b128 a[80:83], v180 offset:0
    ds_read_b128 a[84:87], v181 offset:0
    ds_read_b128 a[88:91], v182 offset:0
    ds_read_b128 a[92:95], v183 offset:0
    s_waitcnt vmcnt(11)
    buffer_load_dwordx4 v[36:39], v203, s[36:39], s28 offen offset:1024
    s_barrier
    s_waitcnt vmcnt(11)
    buffer_load_dwordx4 v[40:43], v203, s[36:39], s28 offen offset:2048
    v_add_u32 v234, 0x10000, v234
    v_add_u32 v235, 0x10000, v235
    v_add_u32 v236, 0x10000, v236
    v_add_u32 v237, 0x10000, v237
    ds_read_b64_tr_b16 a[192:193], v234 offset:0
    ds_read_b64_tr_b16 a[194:195], v235 offset:2048
    ds_read_b64_tr_b16 a[208:209], v236 offset:0
    ds_read_b64_tr_b16 a[210:211], v237 offset:2048
    s_waitcnt vmcnt(11)
    buffer_load_dwordx4 v[44:47], v203, s[36:39], s28 offen offset:3072
    ds_read_b64_tr_b16 a[228:229], v234 offset:8192
    ds_read_b64_tr_b16 a[230:231], v235 offset:10240
    ds_read_b64_tr_b16 a[244:245], v236 offset:8192
    ds_read_b64_tr_b16 a[246:247], v237 offset:10240
    ds_read_b64_tr_b16 a[136:137], v234 offset:16384
    ds_read_b64_tr_b16 a[138:139], v235 offset:18432
    ds_read_b64_tr_b16 a[152:153], v236 offset:16384
    ds_read_b64_tr_b16 a[154:155], v237 offset:18432
    ds_read_b64_tr_b16 a[172:173], v234 offset:24576
    ds_read_b64_tr_b16 a[174:175], v235 offset:26624
    ds_read_b64_tr_b16 a[188:189], v236 offset:24576
    ds_read_b64_tr_b16 a[190:191], v237 offset:26624
    s_waitcnt vmcnt(8)
    ds_read_b128 a[96:99], v176 offset:32768
    ds_read_b128 a[100:103], v177 offset:32768
    ds_read_b128 a[104:107], v178 offset:32768
    ds_read_b128 a[108:111], v179 offset:32768
    ds_read_b128 a[112:115], v180 offset:32768
    ds_read_b128 a[116:119], v181 offset:32768
    ds_read_b128 a[120:123], v182 offset:32768
    ds_read_b128 a[124:127], v183 offset:32768
    s_mov_b32 s63, 0
    s_mov_b32 s62, 0
    s_waitcnt vmcnt(7)
    v_max3_u32 v2, v16, v17, v18
    v_max_u32 v2, v2, v19
    v_cmp_eq_u32 vcc, -1, v2
    s_cmp_eq_u64 vcc, 0
    s_cbranch_scc1 L_qa_ok_6
    buffer_load_dwordx4 v[16:19], v203, s[36:39], s17 offen offset:0 sc1
    s_branch L_qa_s_5
L_qa_ok_6:
    s_bitset1_b32 s62, 0
    ds_write_b128 v194, v[16:19] offset:0
L_qa_s_5:
    s_waitcnt vmcnt(6)
    v_max3_u32 v2, v20, v21, v22
    v_max_u32 v2, v2, v23
    v_cmp_eq_u32 vcc, -1, v2
    s_cmp_eq_u64 vcc, 0
    s_cbranch_scc1 L_qa_ok_8
    buffer_load_dwordx4 v[20:23], v203, s[36:39], s17 offen offset:1024 sc1
    s_branch L_qa_s_7
L_qa_ok_8:
    s_bitset1_b32 s62, 1
    ds_write_b128 v195, v[20:23] offset:1024
L_qa_s_7:
    s_waitcnt vmcnt(5)
    v_max3_u32 v2, v24, v25, v26
    v_max_u32 v2, v2, v27
    v_cmp_eq_u32 vcc, -1, v2
    s_cmp_eq_u64 vcc, 0
    s_cbranch_scc1 L_qa_ok_10
    buffer_load_dwordx4 v[24:27], v203, s[36:39], s17 offen offset:2048 sc1
    s_branch L_qa_s_9
L_qa_ok_10:
    s_bitset1_b32 s62, 2
    ds_write_b128 v196, v[24:27] offset:2048
L_qa_s_9:
    s_waitcnt vmcnt(4)
    v_max3_u32 v2, v28, v29, v30
    v_max_u32 v2, v2, v31
    v_cmp_eq_u32 vcc, -1, v2
    s_cmp_eq_u64 vcc, 0
    s_cbranch_scc1 L_qa_ok_12
    buffer_load_dwordx4 v[28:31], v203, s[36:39], s17 offen offset:3072 sc1
    s_branch L_qa_s_11
L_qa_ok_12:
    s_bitset1_b32 s62, 3
    ds_write_b128 v197, v[28:31] offset:3072
L_qa_s_11:
    s_waitcnt vmcnt(3)
    v_max3_u32 v2, v32, v33, v34
    v_max_u32 v2, v2, v35
    v_cmp_eq_u32 vcc, -1, v2
    s_cmp_eq_u64 vcc, 0
    s_cbranch_scc1 L_qa_ok_14
    buffer_load_dwordx4 v[32:35], v203, s[36:39], s28 offen offset:0 sc1
    s_branch L_qa_s_13
L_qa_ok_14:
    s_bitset1_b32 s62, 4
    ds_write_b128 v198, v[32:35] offset:4096
L_qa_s_13:
    s_waitcnt vmcnt(2)
    v_max3_u32 v2, v36, v37, v38
    v_max_u32 v2, v2, v39
    v_cmp_eq_u32 vcc, -1, v2
    s_cmp_eq_u64 vcc, 0
    s_cbranch_scc1 L_qa_ok_16
    buffer_load_dwordx4 v[36:39], v203, s[36:39], s28 offen offset:1024 sc1
    s_branch L_qa_s_15
L_qa_ok_16:
    s_bitset1_b32 s62, 5
    ds_write_b128 v199, v[36:39] offset:5120
L_qa_s_15:
    s_waitcnt vmcnt(1)
    v_max3_u32 v2, v40, v41, v42
    v_max_u32 v2, v2, v43
    v_cmp_eq_u32 vcc, -1, v2
    s_cmp_eq_u64 vcc, 0
    s_cbranch_scc1 L_qa_ok_18
    buffer_load_dwordx4 v[40:43], v203, s[36:39], s28 offen offset:2048 sc1
    s_branch L_qa_s_17
L_qa_ok_18:
    s_bitset1_b32 s62, 6
    ds_write_b128 v200, v[40:43] offset:6144
L_qa_s_17:
    s_waitcnt vmcnt(0)
    v_max3_u32 v2, v44, v45, v46
    v_max_u32 v2, v2, v47
    v_cmp_eq_u32 vcc, -1, v2
    s_cmp_eq_u64 vcc, 0
    s_cbranch_scc1 L_qa_ok_20
    buffer_load_dwordx4 v[44:47], v203, s[36:39], s28 offen offset:3072 sc1
    s_branch L_qa_s_19
L_qa_ok_20:
    s_bitset1_b32 s62, 7
    ds_write_b128 v201, v[44:47] offset:7168
L_qa_s_19:
    s_cmp_eq_u32 s62, 255
    s_cbranch_scc1 L_qa_done_4
L_qa_poll_3:
    s_waitcnt vmcnt(0)
    s_bitcmp1_b32 s62, 0
    s_cbranch_scc1 L_qa_s_21
    v_max3_u32 v2, v16, v17, v18
    v_max_u32 v2, v2, v19
    v_cmp_eq_u32 vcc, -1, v2
    s_cmp_eq_u64 vcc, 0
    s_cbranch_scc1 L_qa_ok_22
    buffer_load_dwordx4 v[16:19], v203, s[36:39], s17 offen offset:0 sc1
    s_branch L_qa_s_21
L_qa_ok_22:
    s_bitset1_b32 s62, 0
    ds_write_b128 v194, v[16:19] offset:0
L_qa_s_21:
    s_bitcmp1_b32 s62, 1
    s_cbranch_scc1 L_qa_s_23
    v_max3_u32 v2, v20, v21, v22
    v_max_u32 v2, v2, v23
    v_cmp_eq_u32 vcc, -1, v2
    s_cmp_eq_u64 vcc, 0
    s_cbranch_scc1 L_qa_ok_24
    buffer_load_dwordx4 v[20:23], v203, s[36:39], s17 offen offset:1024 sc1
    s_branch L_qa_s_23
L_qa_ok_24:
    s_bitset1_b32 s62, 1
    ds_write_b128 v195, v[20:23] offset:1024
L_qa_s_23:
    s_bitcmp1_b32 s62, 2
    s_cbranch_scc1 L_qa_s_25
    v_max3_u32 v2, v24, v25, v26
    v_max_u32 v2, v2, v27
    v_cmp_eq_u32 vcc, -1, v2
    s_cmp_eq_u64 vcc, 0
    s_cbranch_scc1 L_qa_ok_26
    buffer_load_dwordx4 v[24:27], v203, s[36:39], s17 offen offset:2048 sc1
    s_branch L_qa_s_25
L_qa_ok_26:
    s_bitset1_b32 s62, 2
    ds_write_b128 v196, v[24:27] offset:2048
L_qa_s_25:
    s_bitcmp1_b32 s62, 3
    s_cbranch_scc1 L_qa_s_27
    v_max3_u32 v2, v28, v29, v30
    v_max_u32 v2, v2, v31
    v_cmp_eq_u32 vcc, -1, v2
    s_cmp_eq_u64 vcc, 0
    s_cbranch_scc1 L_qa_ok_28
    buffer_load_dwordx4 v[28:31], v203, s[36:39], s17 offen offset:3072 sc1
    s_branch L_qa_s_27
L_qa_ok_28:
    s_bitset1_b32 s62, 3
    ds_write_b128 v197, v[28:31] offset:3072
L_qa_s_27:
    s_bitcmp1_b32 s62, 4
    s_cbranch_scc1 L_qa_s_29
    v_max3_u32 v2, v32, v33, v34
    v_max_u32 v2, v2, v35
    v_cmp_eq_u32 vcc, -1, v2
    s_cmp_eq_u64 vcc, 0
    s_cbranch_scc1 L_qa_ok_30
    buffer_load_dwordx4 v[32:35], v203, s[36:39], s28 offen offset:0 sc1
    s_branch L_qa_s_29
L_qa_ok_30:
    s_bitset1_b32 s62, 4
    ds_write_b128 v198, v[32:35] offset:4096
L_qa_s_29:
    s_bitcmp1_b32 s62, 5
    s_cbranch_scc1 L_qa_s_31
    v_max3_u32 v2, v36, v37, v38
    v_max_u32 v2, v2, v39
    v_cmp_eq_u32 vcc, -1, v2
    s_cmp_eq_u64 vcc, 0
    s_cbranch_scc1 L_qa_ok_32
    buffer_load_dwordx4 v[36:39], v203, s[36:39], s28 offen offset:1024 sc1
    s_branch L_qa_s_31
L_qa_ok_32:
    s_bitset1_b32 s62, 5
    ds_write_b128 v199, v[36:39] offset:5120
L_qa_s_31:
    s_bitcmp1_b32 s62, 6
    s_cbranch_scc1 L_qa_s_33
    v_max3_u32 v2, v40, v41, v42
    v_max_u32 v2, v2, v43
    v_cmp_eq_u32 vcc, -1, v2
    s_cmp_eq_u64 vcc, 0
    s_cbranch_scc1 L_qa_ok_34
    buffer_load_dwordx4 v[40:43], v203, s[36:39], s28 offen offset:2048 sc1
    s_branch L_qa_s_33
L_qa_ok_34:
    s_bitset1_b32 s62, 6
    ds_write_b128 v200, v[40:43] offset:6144
L_qa_s_33:
    s_bitcmp1_b32 s62, 7
    s_cbranch_scc1 L_qa_s_35
    v_max3_u32 v2, v44, v45, v46
    v_max_u32 v2, v2, v47
    v_cmp_eq_u32 vcc, -1, v2
    s_cmp_eq_u64 vcc, 0
    s_cbranch_scc1 L_qa_ok_36
    buffer_load_dwordx4 v[44:47], v203, s[36:39], s28 offen offset:3072 sc1
    s_branch L_qa_s_35
L_qa_ok_36:
    s_bitset1_b32 s62, 7
    ds_write_b128 v201, v[44:47] offset:7168
L_qa_s_35:
    s_cmp_eq_u32 s62, 255
    s_cbranch_scc1 L_qa_done_4
    s_add_u32 s63, s63, 1
    s_cmp_lt_u32 s63, 20000
    s_cbranch_scc1 L_qa_poll_3
    s_waitcnt vmcnt(0)
L_qa_done_4:
    s_waitcnt lgkmcnt(0)
    s_barrier
    ds_read_b128 v[16:19], v186
    ds_read_b128 v[20:23], v187
    ds_read_b128 v[24:27], v188
    ds_read_b128 v[28:31], v189
    ds_read_b128 v[32:35], v190
    s_waitcnt lgkmcnt(4)
    v_mfma_f32_32x32x16_bf16 v[144:159], a[0:3], v[16:19], 0
    ds_read_b128 v[36:39], v191
    s_waitcnt lgkmcnt(4)
    v_mfma_f32_32x32x16_bf16 v[144:159], a[4:7], v[20:23], v[144:159]
    ds_read_b128 v[40:43], v192
    s_waitcnt lgkmcnt(4)
    v_mfma_f32_32x32x16_bf16 v[144:159], a[8:11], v[24:27], v[144:159]
    ds_read_b128 v[44:47], v193
    s_waitcnt lgkmcnt(4)
    v_mfma_f32_32x32x16_bf16 v[144:159], a[12:15], v[28:31], v[144:159]
    v_xor_b32 v186, 256, v186
    v_xor_b32 v187, 256, v187
    v_xor_b32 v188, 256, v188
    v_xor_b32 v189, 256, v189
    v_xor_b32 v190, 256, v190
    v_xor_b32 v191, 256, v191
    v_xor_b32 v192, 256, v192
    v_xor_b32 v193, 256, v193
    ds_read_b128 v[48:51], v186
    s_waitcnt lgkmcnt(4)
    v_mfma_f32_32x32x16_bf16 v[144:159], a[16:19], v[32:35], v[144:159]
    ds_read_b128 v[52:55], v187
    s_waitcnt lgkmcnt(4)
    v_mfma_f32_32x32x16_bf16 v[144:159], a[20:23], v[36:39], v[144:159]
    s_add_u32 m0, s19, 0
    s_add_u32 s6, s18, 0
    buffer_load_dwordx4 v204, s[52:55], s6 offen nt lds
    ds_read_b128 v[56:59], v188
    s_waitcnt lgkmcnt(4)
    v_mfma_f32_32x32x16_bf16 v[144:159], a[24:27], v[40:43], v[144:159]
    ds_read_b128 v[60:63], v189
    s_waitcnt lgkmcnt(4)
    v_mfma_f32_32x32x16_bf16 v[144:159], a[28:31], v[44:47], v[144:159]
    s_add_u32 m0, s19, 4096
    s_add_u32 s6, s18, 16384
    buffer_load_dwordx4 v204, s[52:55], s6 offen nt lds
    ds_read_b128 v[64:67], v190
    s_waitcnt lgkmcnt(4)
    v_mfma_f32_32x32x16_bf16 v[144:159], a[32:35], v[48:51], v[144:159]
    ds_read_b128 v[68:71], v191
    s_waitcnt lgkmcnt(4)
    v_mfma_f32_32x32x16_bf16 v[144:159], a[36:39], v[52:55], v[144:159]
    s_add_u32 m0, s19, 8192
    s_add_u32 s6, s18, 32768
    buffer_load_dwordx4 v204, s[52:55], s6 offen nt lds
    ds_read_b128 v[72:75], v192
    s_waitcnt lgkmcnt(4)
    v_mfma_f32_32x32x16_bf16 v[144:159], a[40:43], v[56:59], v[144:159]
    ds_read_b128 v[76:79], v193
    s_waitcnt lgkmcnt(4)
    v_mfma_f32_32x32x16_bf16 v[144:159], a[44:47], v[60:63], v[144:159]
    s_add_u32 m0, s19, 12288
    s_add_u32 s6, s18, 49152
    buffer_load_dwordx4 v204, s[52:55], s6 offen nt lds
    v_xor_b32 v186, 768, v186
    v_xor_b32 v187, 768, v187
    v_xor_b32 v188, 768, v188
    v_xor_b32 v189, 768, v189
    v_xor_b32 v190, 768, v190
    v_xor_b32 v191, 768, v191
    v_xor_b32 v192, 768, v192
    v_xor_b32 v193, 768, v193
    ds_read_b128 v[80:83], v186
    s_waitcnt lgkmcnt(4)
    v_mfma_f32_32x32x16_bf16 v[144:159], a[48:51], v[64:67], v[144:159]
    ds_read_b128 v[84:87], v187
    s_waitcnt lgkmcnt(4)
    v_mfma_f32_32x32x16_bf16 v[144:159], a[52:55], v[68:71], v[144:159]
    s_add_u32 m0, s19, 16384
    s_add_u32 s6, s18, 65536
    buffer_load_dwordx4 v204, s[52:55], s6 offen nt lds
    ds_read_b128 v[88:91], v188
    s_waitcnt lgkmcnt(4)
    v_mfma_f32_32x32x16_bf16 v[144:159], a[56:59], v[72:75], v[144:159]
    ds_read_b128 v[92:95], v189
    s_waitcnt lgkmcnt(4)
    v_mfma_f32_32x32x16_bf16 v[144:159], a[60:63], v[76:79], v[144:159]
    s_add_u32 m0, s19, 20480
    s_add_u32 s6, s18, 81920
    buffer_load_dwordx4 v204, s[52:55], s6 offen nt lds
    ds_read_b128 v[96:99], v190
    s_waitcnt lgkmcnt(4)
    v_mfma_f32_32x32x16_bf16 v[144:159], a[64:67], v[80:83], v[144:159]
    ds_read_b128 v[100:103], v191
    s_waitcnt lgkmcnt(4)
    v_mfma_f32_32x32x16_bf16 v[144:159], a[68:71], v[84:87], v[144:159]
    s_add_u32 m0, s19, 24576
    s_add_u32 s6, s18, 98304
    buffer_load_dwordx4 v204, s[52:55], s6 offen nt lds
    ds_read_b128 v[104:107], v192
    s_waitcnt lgkmcnt(4)
    v_mfma_f32_32x32x16_bf16 v[144:159], a[72:75], v[88:91], v[144:159]
    ds_read_b128 v[108:111], v193
    s_waitcnt lgkmcnt(4)
    v_mfma_f32_32x32x16_bf16 v[144:159], a[76:79], v[92:95], v[144:159]
    s_add_u32 m0, s19, 28672
    s_add_u32 s6, s18, 114688
    buffer_load_dwordx4 v204, s[52:55], s6 offen nt lds
    v_xor_b32 v186, 256, v186
    v_xor_b32 v187, 256, v187
    v_xor_b32 v188, 256, v188
    v_xor_b32 v189, 256, v189
    v_xor_b32 v190, 256, v190
    v_xor_b32 v191, 256, v191
    v_xor_b32 v192, 256, v192
    v_xor_b32 v193, 256, v193
    ds_read_b128 v[112:115], v186
    s_waitcnt lgkmcnt(4)
    v_mfma_f32_32x32x16_bf16 v[144:159], a[80:83], v[96:99], v[144:159]
    ds_read_b128 v[116:119], v187
    s_waitcnt lgkmcnt(4)
    v_mfma_f32_32x32x16_bf16 v[144:159], a[84:87], v[100:103], v[144:159]
    ds_read_b128 v[120:123], v188
    s_waitcnt lgkmcnt(4)
    v_mfma_f32_32x32x16_bf16 v[144:159], a[88:91], v[104:107], v[144:159]
    ds_read_b128 v[124:127], v189
    s_waitcnt lgkmcnt(4)
    v_mfma_f32_32x32x16_bf16 v[144:159], a[92:95], v[108:111], v[144:159]
    ds_read_b128 v[128:131], v190
    s_waitcnt lgkmcnt(4)
    v_mfma_f32_32x32x16_bf16 v[144:159], a[96:99], v[112:115], v[144:159]
    ds_read_b128 v[132:135], v191
    s_waitcnt lgkmcnt(4)
    v_mfma_f32_32x32x16_bf16 v[144:159], a[100:103], v[116:119], v[144:159]
    ds_read_b128 v[136:139], v192
    s_waitcnt lgkmcnt(4)
    v_mfma_f32_32x32x16_bf16 v[144:159], a[104:107], v[120:123], v[144:159]
    ds_read_b128 v[140:143], v193
    s_waitcnt lgkmcnt(4)
    v_mfma_f32_32x32x16_bf16 v[144:159], a[108:111], v[124:127], v[144:159]
    s_waitcnt lgkmcnt(3)
    v_mfma_f32_32x32x16_bf16 v[144:159], a[112:115], v[128:131], v[144:159]
    s_waitcnt lgkmcnt(2)
    v_mfma_f32_32x32x16_bf16 v[144:159], a[116:119], v[132:135], v[144:159]
    s_waitcnt lgkmcnt(1)
    v_mfma_f32_32x32x16_bf16 v[144:159], a[120:123], v[136:139], v[144:159]
    s_waitcnt lgkmcnt(0)
    v_mfma_f32_32x32x16_bf16 v[144:159], a[124:127], v[140:143], v[144:159]
    ds_read_b64_tr_b16 a[224:225], v234 offset:32768
    ds_read_b64_tr_b16 a[226:227], v235 offset:34816
    ds_read_b64_tr_b16 a[240:241], v236 offset:32768
    ds_read_b64_tr_b16 a[242:243], v237 offset:34816
    ds_read_b64_tr_b16 a[196:197], v234 offset:40960
    ds_read_b64_tr_b16 a[198:199], v235 offset:43008
    ds_read_b64_tr_b16 a[212:213], v236 offset:40960
    ds_read_b64_tr_b16 a[214:215], v237 offset:43008
    ds_read_b64_tr_b16 a[168:169], v234 offset:49152
    ds_read_b64_tr_b16 a[170:171], v235 offset:51200
    ds_read_b64_tr_b16 a[184:185], v236 offset:49152
    ds_read_b64_tr_b16 a[186:187], v237 offset:51200
    ds_read_b64_tr_b16 a[140:141], v234 offset:57344
    ds_read_b64_tr_b16 a[142:143], v235 offset:59392
    ds_read_b64_tr_b16 a[156:157], v236 offset:57344
    ds_read_b64_tr_b16 a[158:159], v237 offset:59392
    v_max3_f32 v2, v144, v145, v146
    v_max3_f32 v3, v147, v148, v149
    v_max3_f32 v2, v2, v150, v151
    v_max3_f32 v3, v3, v152, v153
    v_max3_f32 v2, v2, v154, v155
    v_max3_f32 v3, v3, v156, v157
    v_max3_f32 v2, v2, v158, v159
    v_max_f32 v2, v2, v3
    v_mov_b32 v3, v2
    s_nop 1
    v_permlane32_swap_b32 v2, v3
    v_max_f32 v2, v2, v3
    ds_write_b32 v238, v2
    s_waitcnt lgkmcnt(0)
    s_barrier
    ds_read_b128 v[16:19], v239
    s_waitcnt lgkmcnt(0)
    v_max3_f32 v2, v16, v17, v18
    v_max_f32 v160, v2, v19
    v_sub_f32 v144, v144, v160
    v_sub_f32 v145, v145, v160
    v_sub_f32 v146, v146, v160
    v_sub_f32 v147, v147, v160
    v_sub_f32 v148, v148, v160
    v_sub_f32 v149, v149, v160
    v_sub_f32 v150, v150, v160
    v_sub_f32 v151, v151, v160
    v_sub_f32 v152, v152, v160
    v_sub_f32 v153, v153, v160
    v_sub_f32 v154, v154, v160
    v_sub_f32 v155, v155, v160
    v_sub_f32 v156, v156, v160
    v_sub_f32 v157, v157, v160
    v_sub_f32 v158, v158, v160
    v_sub_f32 v159, v159, v160
    v_exp_f32 v144, v144
    v_exp_f32 v145, v145
    v_exp_f32 v146, v146
    v_exp_f32 v147, v147
    v_exp_f32 v148, v148
    v_exp_f32 v149, v149
    v_exp_f32 v150, v150
    v_exp_f32 v151, v151
    v_exp_f32 v152, v152
    v_exp_f32 v153, v153
    v_exp_f32 v154, v154
    v_exp_f32 v155, v155
    v_exp_f32 v156, v156
    v_exp_f32 v157, v157
    v_exp_f32 v158, v158
    v_exp_f32 v159, v159
    v_cvt_pk_bf16_f32 v16, v144, v145
    v_cvt_pk_bf16_f32 v17, v146, v147
    v_cvt_pk_bf16_f32 v18, v148, v149
    v_cvt_pk_bf16_f32 v19, v150, v151
    v_cvt_pk_bf16_f32 v20, v152, v153
    v_cvt_pk_bf16_f32 v21, v154, v155
    v_cvt_pk_bf16_f32 v22, v156, v157
    v_cvt_pk_bf16_f32 v23, v158, v159
    ds_write_b128 v240, v[16:19]
    ds_write_b128 v240, v[20:23] offset:1024
    v_pk_add_f32 v[144:145], v[144:145], v[152:153]
    v_pk_add_f32 v[146:147], v[146:147], v[154:155]
    v_pk_add_f32 v[148:149], v[148:149], v[156:157]
    v_pk_add_f32 v[150:151], v[150:151], v[158:159]
    v_pk_add_f32 v[144:145], v[144:145], v[148:149]
    v_pk_add_f32 v[146:147], v[146:147], v[150:151]
    v_pk_add_f32 v[144:145], v[144:145], v[146:147]
    v_add_f32 v2, v144, v145
    v_mov_b32 v3, v2
    s_nop 1
    v_permlane32_swap_b32 v2, v3
    v_add_f32 v2, v2, v3
    ds_write_b32 v238, v2 offset:512
    s_waitcnt lgkmcnt(0)
    s_barrier
    ds_read_b128 v[16:19], v241 offset:0
    ds_read_b128 v[20:23], v241 offset:2048
    ds_read_b128 v[24:27], v241 offset:4096
    ds_read_b128 v[28:31], v241 offset:6144
    ds_read_b128 v[32:35], v241 offset:256
    ds_read_b128 v[36:39], v241 offset:2304
    ds_read_b128 v[40:43], v241 offset:4352
    ds_read_b128 v[44:47], v241 offset:6400
    ds_read_b128 v[164:167], v239 offset:512
    s_waitcnt lgkmcnt(8)
    v_mfma_f32_16x16x32_bf16 v[48:51], v[16:19], a[128:131], 0
    v_mfma_f32_16x16x32_bf16 v[52:55], v[16:19], a[160:163], 0
    v_mfma_f32_16x16x32_bf16 v[56:59], v[16:19], a[192:195], 0
    v_mfma_f32_16x16x32_bf16 v[60:63], v[16:19], a[224:227], 0
    v_mfma_f32_16x16x32_bf16 v[64:67], v[16:19], a[144:147], 0
    v_mfma_f32_16x16x32_bf16 v[68:71], v[16:19], a[176:179], 0
    v_mfma_f32_16x16x32_bf16 v[72:75], v[16:19], a[208:211], 0
    v_mfma_f32_16x16x32_bf16 v[76:79], v[16:19], a[240:243], 0
    s_waitcnt lgkmcnt(7)
    v_mfma_f32_16x16x32_bf16 v[48:51], v[20:23], a[132:135], v[48:51]
    v_mfma_f32_16x16x32_bf16 v[52:55], v[20:23], a[164:167], v[52:55]
    v_mfma_f32_16x16x32_bf16 v[56:59], v[20:23], a[196:199], v[56:59]
    v_mfma_f32_16x16x32_bf16 v[60:63], v[20:23], a[228:231], v[60:63]
    v_mfma_f32_16x16x32_bf16 v[64:67], v[20:23], a[148:151], v[64:67]
    v_mfma_f32_16x16x32_bf16 v[68:71], v[20:23], a[180:183], v[68:71]
    v_mfma_f32_16x16x32_bf16 v[72:75], v[20:23], a[212:215], v[72:75]
    v_mfma_f32_16x16x32_bf16 v[76:79], v[20:23], a[244:247], v[76:79]
    s_waitcnt lgkmcnt(6)
    v_mfma_f32_16x16x32_bf16 v[48:51], v[24:27], a[136:139], v[48:51]
    v_mfma_f32_16x16x32_bf16 v[52:55], v[24:27], a[168:171], v[52:55]
    v_mfma_f32_16x16x32_bf16 v[56:59], v[24:27], a[200:203], v[56:59]
    v_mfma_f32_16x16x32_bf16 v[60:63], v[24:27], a[232:235], v[60:63]
    v_mfma_f32_16x16x32_bf16 v[64:67], v[24:27], a[152:155], v[64:67]
    v_mfma_f32_16x16x32_bf16 v[68:71], v[24:27], a[184:187], v[68:71]
    v_mfma_f32_16x16x32_bf16 v[72:75], v[24:27], a[216:219], v[72:75]
    v_mfma_f32_16x16x32_bf16 v[76:79], v[24:27], a[248:251], v[76:79]
    s_waitcnt lgkmcnt(5)
    v_mfma_f32_16x16x32_bf16 v[48:51], v[28:31], a[140:143], v[48:51]
    v_mfma_f32_16x16x32_bf16 v[52:55], v[28:31], a[172:175], v[52:55]
    v_mfma_f32_16x16x32_bf16 v[56:59], v[28:31], a[204:207], v[56:59]
    v_mfma_f32_16x16x32_bf16 v[60:63], v[28:31], a[236:239], v[60:63]
    v_mfma_f32_16x16x32_bf16 v[64:67], v[28:31], a[156:159], v[64:67]
    v_mfma_f32_16x16x32_bf16 v[68:71], v[28:31], a[188:191], v[68:71]
    v_mfma_f32_16x16x32_bf16 v[72:75], v[28:31], a[220:223], v[72:75]
    v_mfma_f32_16x16x32_bf16 v[76:79], v[28:31], a[252:255], v[76:79]
    s_waitcnt lgkmcnt(4)
    v_mfma_f32_16x16x32_bf16 v[80:83], v[32:35], a[128:131], 0
    v_mfma_f32_16x16x32_bf16 v[84:87], v[32:35], a[160:163], 0
    v_mfma_f32_16x16x32_bf16 v[88:91], v[32:35], a[192:195], 0
    v_mfma_f32_16x16x32_bf16 v[92:95], v[32:35], a[224:227], 0
    v_mfma_f32_16x16x32_bf16 v[96:99], v[32:35], a[144:147], 0
    v_cvt_pk_bf16_f32 v112, v48, v52
    v_cvt_pk_bf16_f32 v113, v56, v60
    v_mfma_f32_16x16x32_bf16 v[100:103], v[32:35], a[176:179], 0
    v_cvt_pk_bf16_f32 v114, v64, v68
    v_cvt_pk_bf16_f32 v115, v72, v76
    v_mfma_f32_16x16x32_bf16 v[104:107], v[32:35], a[208:211], 0
    buffer_store_dwordx4 v[112:115], v203, s[36:39], s16 offen offset:0 sc1
    v_cvt_pk_bf16_f32 v116, v49, v53
    v_mfma_f32_16x16x32_bf16 v[108:111], v[32:35], a[240:243], 0
    v_cvt_pk_bf16_f32 v117, v57, v61
    v_cvt_pk_bf16_f32 v118, v65, v69
    s_waitcnt lgkmcnt(3)
    v_mfma_f32_16x16x32_bf16 v[80:83], v[36:39], a[132:135], v[80:83]
    v_cvt_pk_bf16_f32 v119, v73, v77
    buffer_store_dwordx4 v[116:119], v203, s[36:39], s16 offen offset:1024 sc1
    v_mfma_f32_16x16x32_bf16 v[84:87], v[36:39], a[164:167], v[84:87]
    v_cvt_pk_bf16_f32 v120, v50, v54
    v_cvt_pk_bf16_f32 v121, v58, v62
    v_mfma_f32_16x16x32_bf16 v[88:91], v[36:39], a[196:199], v[88:91]
    v_cvt_pk_bf16_f32 v122, v66, v70
    v_cvt_pk_bf16_f32 v123, v74, v78
    v_mfma_f32_16x16x32_bf16 v[92:95], v[36:39], a[228:231], v[92:95]
    buffer_store_dwordx4 v[120:123], v203, s[36:39], s16 offen offset:2048 sc1
    v_cvt_pk_bf16_f32 v124, v51, v55
    v_mfma_f32_16x16x32_bf16 v[96:99], v[36:39], a[148:151], v[96:99]
    v_cvt_pk_bf16_f32 v125, v59, v63
    v_cvt_pk_bf16_f32 v126, v67, v71
    v_mfma_f32_16x16x32_bf16 v[100:103], v[36:39], a[180:183], v[100:103]
    v_cvt_pk_bf16_f32 v127, v75, v79
    buffer_store_dwordx4 v[124:127], v203, s[36:39], s16 offen offset:3072 sc1
    v_mfma_f32_16x16x32_bf16 v[104:107], v[36:39], a[212:215], v[104:107]
    v_mfma_f32_16x16x32_bf16 v[108:111], v[36:39], a[244:247], v[108:111]
    s_waitcnt lgkmcnt(2)
    v_mfma_f32_16x16x32_bf16 v[80:83], v[40:43], a[136:139], v[80:83]
    v_mfma_f32_16x16x32_bf16 v[84:87], v[40:43], a[168:171], v[84:87]
    v_mfma_f32_16x16x32_bf16 v[88:91], v[40:43], a[200:203], v[88:91]
    v_mfma_f32_16x16x32_bf16 v[92:95], v[40:43], a[232:235], v[92:95]
    v_mfma_f32_16x16x32_bf16 v[96:99], v[40:43], a[152:155], v[96:99]
    v_mfma_f32_16x16x32_bf16 v[100:103], v[40:43], a[184:187], v[100:103]
    v_mfma_f32_16x16x32_bf16 v[104:107], v[40:43], a[216:219], v[104:107]
    v_mfma_f32_16x16x32_bf16 v[108:111], v[40:43], a[248:251], v[108:111]
    s_waitcnt lgkmcnt(1)
    v_mfma_f32_16x16x32_bf16 v[80:83], v[44:47], a[140:143], v[80:83]
    v_mfma_f32_16x16x32_bf16 v[84:87], v[44:47], a[172:175], v[84:87]
    v_mfma_f32_16x16x32_bf16 v[88:91], v[44:47], a[204:207], v[88:91]
    v_mfma_f32_16x16x32_bf16 v[92:95], v[44:47], a[236:239], v[92:95]
    v_mfma_f32_16x16x32_bf16 v[96:99], v[44:47], a[156:159], v[96:99]
    v_mfma_f32_16x16x32_bf16 v[100:103], v[44:47], a[188:191], v[100:103]
    v_mfma_f32_16x16x32_bf16 v[104:107], v[44:47], a[220:223], v[104:107]
    v_mfma_f32_16x16x32_bf16 v[108:111], v[44:47], a[252:255], v[108:111]
    s_waitcnt lgkmcnt(0)
    v_add_f32 v164, v164, v165
    v_add_f32 v166, v166, v167
    v_mov_b32 v162, s4
    v_mov_b32 v163, s5
    v_add_f32 v161, v164, v166
    v_cvt_pk_bf16_f32 v128, v80, v84
    v_cvt_pk_bf16_f32 v129, v88, v92
    v_cvt_pk_bf16_f32 v130, v96, v100
    v_cvt_pk_bf16_f32 v131, v104, v108
    buffer_store_dwordx4 v[128:131], v203, s[36:39], s29 offen offset:0 sc1
    v_cvt_pk_bf16_f32 v132, v81, v85
    v_cvt_pk_bf16_f32 v133, v89, v93
    v_cvt_pk_bf16_f32 v134, v97, v101
    v_cvt_pk_bf16_f32 v135, v105, v109
    buffer_store_dwordx4 v[132:135], v203, s[36:39], s29 offen offset:1024 sc1
    v_cvt_pk_bf16_f32 v136, v82, v86
    v_cvt_pk_bf16_f32 v137, v90, v94
    v_cvt_pk_bf16_f32 v138, v98, v102
    v_cvt_pk_bf16_f32 v139, v106, v110
    buffer_store_dwordx4 v[136:139], v203, s[36:39], s29 offen offset:2048 sc1
    v_cvt_pk_bf16_f32 v140, v83, v87
    v_cvt_pk_bf16_f32 v141, v91, v95
    v_cvt_pk_bf16_f32 v142, v99, v103
    v_cvt_pk_bf16_f32 v143, v107, v111
    buffer_store_dwordx4 v[140:143], v203, s[36:39], s29 offen offset:3072 sc1
    s_waitcnt vmcnt(4)
    s_mov_b64 exec, 0xffff
    buffer_store_dwordx4 v[160:163], v219, s[36:39], s20 offen sc1
    s_waitcnt vmcnt(1)
    s_mov_b64 exec, 0xffff0000
    buffer_store_dwordx4 v[160:163], v219, s[36:39], s20 offen sc1
    s_mov_b64 exec, -1
    buffer_load_dwordx4 v[168:171], v218, s[36:39], s21 offen sc1
    s_barrier
    ds_read_b64_tr_b16 v[48:49], v228 offset:0
    ds_read_b64_tr_b16 v[50:51], v228 offset:1024
    ds_read_b64_tr_b16 v[52:53], v228 offset:8192
    ds_read_b64_tr_b16 v[54:55], v228 offset:9216
    ds_read_b64_tr_b16 v[56:57], v228 offset:16384
    ds_read_b64_tr_b16 v[58:59], v228 offset:17408
    ds_read_b64_tr_b16 v[60:61], v228 offset:24576
    ds_read_b64_tr_b16 v[62:63], v228 offset:25600
    ds_read_b64_tr_b16 v[64:65], v229 offset:0
    ds_read_b64_tr_b16 v[66:67], v229 offset:1024
    ds_read_b64_tr_b16 v[68:69], v229 offset:8192
    ds_read_b64_tr_b16 v[70:71], v229 offset:9216
    ds_read_b64_tr_b16 v[72:73], v229 offset:16384
    ds_read_b64_tr_b16 v[74:75], v229 offset:17408
    ds_read_b64_tr_b16 v[76:77], v229 offset:24576
    ds_read_b64_tr_b16 v[78:79], v229 offset:25600
    s_mov_b32 s63, 0
    s_waitcnt vmcnt(0)
    v_cmp_ne_u64 vcc, s[4:5], v[170:171]
    s_cmp_eq_u64 vcc, 0
    s_cbranch_scc1 L_ml_rd0_39
    buffer_load_dwordx4 v[168:171], v218, s[36:39], s21 offen sc1
L_ml_rp_37:
    s_waitcnt vmcnt(0)
    v_cmp_ne_u64 vcc, s[4:5], v[170:171]
    s_cmp_eq_u64 vcc, 0
    s_cbranch_scc1 L_ml_rd0_39
    buffer_load_dwordx4 v[168:171], v218, s[36:39], s21 offen sc1
    s_add_u32 s63, s63, 1
    s_cmp_lt_u32 s63, 20000
    s_cbranch_scc1 L_ml_rp_37
    s_waitcnt vmcnt(0)
L_ml_rd0_39:
    buffer_load_dwordx4 v[80:83], v202, s[36:39], s22 offen sc1
    v_mov_b32 v16, v168
    v_mov_b32 v17, v169
L_ml_re_38:
    s_add_u32 s22, s22, 0x20000
    buffer_load_dwordx4 v[84:87], v202, s[36:39], s22 offen sc1
    s_add_u32 s22, s22, 0x20000
    buffer_load_dwordx4 v[88:91], v202, s[36:39], s22 offen sc1
    s_add_u32 s22, s22, 0x20000
    buffer_load_dwordx4 v[92:95], v202, s[36:39], s22 offen sc1
    s_add_u32 s22, s22, 0x20000
    buffer_load_dwordx4 v[96:99], v202, s[36:39], s22 offen sc1
    s_add_u32 s22, s22, 0x20000
    buffer_load_dwordx4 v[100:103], v202, s[36:39], s22 offen sc1
    s_add_u32 s22, s22, 0x20000
    buffer_load_dwordx4 v[104:107], v202, s[36:39], s22 offen sc1
    s_add_u32 s22, s22, 0x20000
    buffer_load_dwordx4 v[108:111], v202, s[36:39], s22 offen sc1
    v_mov_b32 v20, v16
    s_nop 1
    v_max_f32_dpp v20, v20, v20 row_ror:8 row_mask:0xf bank_mask:0xf
    s_nop 1
    v_max_f32_dpp v20, v20, v20 row_ror:4 row_mask:0xf bank_mask:0xf
    s_nop 1
    v_max_f32_dpp v20, v20, v20 row_ror:2 row_mask:0xf bank_mask:0xf
    s_nop 1
    v_max_f32_dpp v20, v20, v20 row_ror:1 row_mask:0xf bank_mask:0xf
    v_mov_b32 v21, v20
    s_nop 1
    v_permlane16_swap_b32 v20, v21
    v_max_f32 v20, v20, v21
    v_sub_f32 v20, v16, v20
    v_exp_f32 v20, v20
    s_nop 0
    v_mul_f32 v22, v20, v17
    s_nop 1
    v_add_f32_dpp v22, v22, v22 row_ror:8 row_mask:0xf bank_mask:0xf
    s_nop 1
    v_add_f32_dpp v22, v22, v22 row_ror:4 row_mask:0xf bank_mask:0xf
    s_nop 1
    v_add_f32_dpp v22, v22, v22 row_ror:2 row_mask:0xf bank_mask:0xf
    s_nop 1
    v_add_f32_dpp v22, v22, v22 row_ror:1 row_mask:0xf bank_mask:0xf
    v_mov_b32 v21, v22
    s_nop 1
    v_permlane16_swap_b32 v22, v21
    v_add_f32 v22, v22, v21
    v_rcp_f32 v22, v22
    s_nop 0
    v_mul_f32 v20, v20, v22
    v_cvt_pk_bf16_f32 v20, v20, v20
    ds_write_b32 v230, v20
    s_waitcnt lgkmcnt(0)
    ds_read_b128 v[16:19], v231
    ds_read_b128 v[20:23], v231 offset:16
    s_waitcnt lgkmcnt(0)
    v_and_b32 v112, v16, v10
    v_and_b32 v113, v16, v11
    v_and_b32 v114, v16, v12
    v_and_b32 v115, v16, v13
    v_and_b32 v116, v17, v10
    v_and_b32 v117, v17, v11
    v_and_b32 v118, v17, v12
    v_and_b32 v119, v17, v13
    v_and_b32 v120, v18, v10
    v_and_b32 v121, v18, v11
    v_and_b32 v122, v18, v12
    v_and_b32 v123, v18, v13
    v_and_b32 v124, v19, v10
    v_and_b32 v125, v19, v11
    v_and_b32 v126, v19, v12
    v_and_b32 v127, v19, v13
    v_and_b32 v128, v20, v10
    v_and_b32 v129, v20, v11
    v_and_b32 v130, v20, v12
    v_and_b32 v131, v20, v13
    v_and_b32 v132, v21, v10
    v_and_b32 v133, v21, v11
    v_and_b32 v134, v21, v12
    v_and_b32 v135, v21, v13
    v_and_b32 v136, v22, v10
    v_and_b32 v137, v22, v11
    v_and_b32 v138, v22, v12
    v_and_b32 v139, v22, v13
    v_and_b32 v140, v23, v10
    v_and_b32 v141, v23, v11
    v_and_b32 v142, v23, v12
    v_and_b32 v143, v23, v13
    v_mov_b32 v42, s4
    v_mov_b32 v43, s5
    v_cmp_eq_u32 vcc, 1, v232
    s_waitcnt vmcnt(7)
    v_mfma_f32_16x16x32_bf16 v[24:27], v[112:115], v[80:83], 0
    s_waitcnt vmcnt(6)
    v_mfma_f32_16x16x32_bf16 v[24:27], v[116:119], v[84:87], v[24:27]
    s_waitcnt vmcnt(5)
    v_mfma_f32_16x16x32_bf16 v[24:27], v[120:123], v[88:91], v[24:27]
    s_waitcnt vmcnt(4)
    v_mfma_f32_16x16x32_bf16 v[24:27], v[124:127], v[92:95], v[24:27]
    s_waitcnt vmcnt(3)
    v_mfma_f32_16x16x32_bf16 v[24:27], v[128:131], v[96:99], v[24:27]
    s_waitcnt vmcnt(2)
    v_mfma_f32_16x16x32_bf16 v[24:27], v[132:135], v[100:103], v[24:27]
    s_waitcnt vmcnt(1)
    v_mfma_f32_16x16x32_bf16 v[24:27], v[136:139], v[104:107], v[24:27]
    s_waitcnt vmcnt(0)
    v_mfma_f32_16x16x32_bf16 v[24:27], v[140:143], v[108:111], v[24:27]
    s_nop 7
    v_cvt_pk_bf16_f32 v28, v24, v25
    v_cvt_pk_bf16_f32 v29, v26, v27
    ds_write_b64 v205, v[28:29]
    s_waitcnt lgkmcnt(0)
    s_barrier
    ds_read_b128 v[144:147], v206 offset:0
    ds_read_b128 v[148:151], v206 offset:64
    ds_read_b128 v[152:155], v206 offset:128
    ds_read_b128 v[156:159], v206 offset:192
    s_waitcnt lgkmcnt(3)
    v_mfma_f32_16x16x32_bf16 v[32:35], v[48:51], v[144:147], 0
    v_mfma_f32_16x16x32_bf16 v[36:39], v[64:67], v[144:147], 0
    s_waitcnt lgkmcnt(2)
    v_mfma_f32_16x16x32_bf16 v[32:35], v[52:55], v[148:151], v[32:35]
    v_mfma_f32_16x16x32_bf16 v[36:39], v[68:71], v[148:151], v[36:39]
    s_waitcnt lgkmcnt(1)
    v_mfma_f32_16x16x32_bf16 v[32:35], v[56:59], v[152:155], v[32:35]
    v_mfma_f32_16x16x32_bf16 v[36:39], v[72:75], v[152:155], v[36:39]
    s_waitcnt lgkmcnt(0)
    v_mfma_f32_16x16x32_bf16 v[32:35], v[60:63], v[156:159], v[32:35]
    v_mfma_f32_16x16x32_bf16 v[36:39], v[76:79], v[156:159], v[36:39]
    s_nop 6
    v_cvt_pk_bf16_f32 v28, v32, v33
    v_cvt_pk_bf16_f32 v29, v34, v35
    v_cvt_pk_bf16_f32 v30, v36, v37
    v_cvt_pk_bf16_f32 v31, v38, v39
    v_cndmask_b32 v40, v28, v30, vcc
    v_cndmask_b32 v41, v29, v31, vcc
    s_mov_b32 s6, 0x33333333
    s_mov_b32 exec_lo, s6
    s_mov_b32 exec_hi, s6
    s_xor_b32 s6, s24, 7340032
    buffer_store_dwordx4 v[40:43], v207, s[36:39], s6 offen
    buffer_store_dwordx4 v[40:43], v207, s[36:39], s24 offen sc1
    s_endpgm
L_notatt2:
    v_and_b32 v2, 1, v1
    v_lshlrev_b32 v2, 4, v2
    v_mov_b32 v3, 0xffff
    v_lshlrev_b32 v2, v2, v3
    v_bfe_u32 v3, v1, 1, 2
    v_cmp_eq_u32 vcc, 0, v3
    s_nop 1
    v_cndmask_b32 v10, 0, v2, vcc
    v_cmp_eq_u32 vcc, 1, v3
    s_nop 1
    v_cndmask_b32 v11, 0, v2, vcc
    v_cmp_eq_u32 vcc, 2, v3
    s_nop 1
    v_cndmask_b32 v12, 0, v2, vcc
    v_cmp_eq_u32 vcc, 3, v3
    s_nop 1
    v_cndmask_b32 v13, 0, v2, vcc
    v_mov_b32 v2, 0x0c0c0c0c
    s_mov_b32 s6, 0x01000100
    s_mov_b32 s7, 0x03020302
    v_bfi_b32 v64, v10, s6, v2
    v_bfi_b32 v68, v10, s7, v2
    v_and_b32 v192, 0x3f803f80, v10
    v_bfi_b32 v65, v11, s6, v2
    v_bfi_b32 v69, v11, s7, v2
    v_and_b32 v193, 0x3f803f80, v11
    v_bfi_b32 v66, v12, s6, v2
    v_bfi_b32 v70, v12, s7, v2
    v_and_b32 v194, 0x3f803f80, v12
    v_bfi_b32 v67, v13, s6, v2
    v_bfi_b32 v71, v13, s7, v2
    v_and_b32 v195, 0x3f803f80, v13
    s_mul_i32 s6, s3, 3072
    s_add_u32 s6, s6, 131072
    v_lshl_add_u32 v196, v1, 4, s6
    s_lshl_b32 s14, s3, 10
    s_add_u32 s6, s14, 131072
    v_lshl_add_u32 v197, v1, 4, s6
    v_lshlrev_b32 v198, 4, v1
    v_add_u32 v198, 133120, v198
    s_lshl_b32 s6, s3, 3
    s_add_u32 s6, s6, 143360
    v_mov_b32 v199, s6
    s_lshl_b32 s6, s3, 4
    s_add_u32 s6, s6, 143360
    v_lshrrev_b32 v5, 5, v1
    v_lshl_add_u32 v200, v5, 3, s6
    s_lshl_b32 s15, s8, 2
    s_add_u32 s15, s15, s9
    s_lshl_b32 s15, s15, 11
    s_add_u32 s15, s15, s14
    s_add_u32 s15, s15, 65536
    v_lshlrev_b32 v5, 9, v5
    v_lshl_add_u32 v5, v15, 5, v5
    v_and_b32 v7, 1, v14
    v_lshl_add_u32 v5, v7, 4, v5
    s_lshl_b32 s6, s3, 11
    v_lshl_add_u32 v20, v1, 4, s6
    v_lshrrev_b32 v2, 5, v1
    v_mul_u32_u24 v2, 1088, v2
    v_and_b32 v3, 31, v1
    v_lshl_add_u32 v2, v3, 3, v2
    s_mul_i32 s6, s3, 272
    s_add_u32 s6, s6, 147456
    v_add_u32 v21, s6, v2
    v_and_b32 v2, 15, v1
    v_mul_u32_u24 v2, 272, v2
    v_lshrrev_b32 v3, 4, v1
    v_lshl_add_u32 v2, v3, 4, v2
    v_add_u32 v22, 147456, v2
    s_lshl_b32 s13, s8, 13
    s_add_u32 s13, s13, 65536
    s_xor_b32 s17, s15, 7340032
    v_xor_b32 v2, v14, v15
    v_lshlrev_b32 v2, 4, v2
    v_lshl_add_u32 v2, v15, 9, v2
    v_add_u32 v32, s11, v2
    v_xor_b32 v33, 64, v32
    v_xor_b32 v34, 128, v32
    v_xor_b32 v35, 192, v32
    s_waitcnt vmcnt(16)
    v_perm_b32 v72, v52, v52, v64
    v_perm_b32 v73, v52, v52, v65
    v_perm_b32 v74, v52, v52, v66
    v_perm_b32 v75, v52, v52, v67
    v_perm_b32 v76, v58, v58, v64
    v_perm_b32 v77, v58, v58, v65
    v_perm_b32 v78, v58, v58, v66
    v_perm_b32 v79, v58, v58, v67
    v_perm_b32 v80, v52, v52, v68
    v_perm_b32 v81, v52, v52, v69
    v_perm_b32 v82, v52, v52, v70
    v_perm_b32 v83, v52, v52, v71
    v_perm_b32 v84, v58, v58, v68
    v_perm_b32 v85, v58, v58, v69
    v_perm_b32 v86, v58, v58, v70
    v_perm_b32 v87, v58, v58, v71
    v_perm_b32 v88, v53, v53, v64
    v_perm_b32 v89, v53, v53, v65
    v_perm_b32 v90, v53, v53, v66
    v_perm_b32 v91, v53, v53, v67
    v_perm_b32 v92, v59, v59, v64
    v_perm_b32 v93, v59, v59, v65
    v_perm_b32 v94, v59, v59, v66
    v_perm_b32 v95, v59, v59, v67
    v_perm_b32 v96, v53, v53, v68
    v_perm_b32 v97, v53, v53, v69
    v_perm_b32 v98, v53, v53, v70
    v_perm_b32 v99, v53, v53, v71
    v_perm_b32 v100, v59, v59, v68
    v_perm_b32 v101, v59, v59, v69
    v_perm_b32 v102, v59, v59, v70
    v_perm_b32 v103, v59, v59, v71
    v_perm_b32 v104, v54, v54, v64
    v_perm_b32 v105, v54, v54, v65
    v_perm_b32 v106, v54, v54, v66
    v_perm_b32 v107, v54, v54, v67
    v_perm_b32 v108, v60, v60, v64
    v_perm_b32 v109, v60, v60, v65
    v_perm_b32 v110, v60, v60, v66
    v_perm_b32 v111, v60, v60, v67
    v_perm_b32 v112, v54, v54, v68
    v_perm_b32 v113, v54, v54, v69
    v_perm_b32 v114, v54, v54, v70
    v_perm_b32 v115, v54, v54, v71
    v_perm_b32 v116, v60, v60, v68
    v_perm_b32 v117, v60, v60, v69
    v_perm_b32 v118, v60, v60, v70
    v_perm_b32 v119, v60, v60, v71
    v_perm_b32 v120, v55, v55, v64
    v_perm_b32 v121, v55, v55, v65
    v_perm_b32 v122, v55, v55, v66
    v_perm_b32 v123, v55, v55, v67
    v_perm_b32 v124, v61, v61, v64
    v_perm_b32 v125, v61, v61, v65
    v_perm_b32 v126, v61, v61, v66
    v_perm_b32 v127, v61, v61, v67
    v_perm_b32 v128, v55, v55, v68
    v_perm_b32 v129, v55, v55, v69
    v_perm_b32 v130, v55, v55, v70
    v_perm_b32 v131, v55, v55, v71
    v_perm_b32 v132, v61, v61, v68
    v_perm_b32 v133, v61, v61, v69
    v_perm_b32 v134, v61, v61, v70
    v_perm_b32 v135, v61, v61, v71
    v_perm_b32 v136, v56, v56, v64
    v_perm_b32 v137, v56, v56, v65
    v_perm_b32 v138, v56, v56, v66
    v_perm_b32 v139, v56, v56, v67
    v_perm_b32 v140, v62, v62, v64
    v_perm_b32 v141, v62, v62, v65
    v_perm_b32 v142, v62, v62, v66
    v_perm_b32 v143, v62, v62, v67
    s_waitcnt vmcnt(13)
    v_readfirstlane_b32 s4, v8
    v_readfirstlane_b32 s5, v9
    s_add_u32 s4, s4, 1
    s_addc_u32 s5, s5, 0
    v_mov_b32 v40, s4
    v_mov_b32 v41, s5
    s_mov_b32 s7, 0xffff0000
    v_lshlrev_b32 v164, 16, v156
    v_and_b32 v165, s7, v156
    v_lshlrev_b32 v166, 16, v157
    v_and_b32 v167, s7, v157
    v_lshlrev_b32 v168, 16, v158
    v_and_b32 v169, s7, v158
    v_lshlrev_b32 v170, 16, v159
    v_and_b32 v171, s7, v159
    v_lshlrev_b32 v172, 16, v160
    v_readfirstlane_b32 s6, v164
    s_nop 1
    v_subrev_f32 v176, s6, v164
    v_subrev_f32 v177, s6, v165
    v_subrev_f32 v178, s6, v166
    v_subrev_f32 v179, s6, v167
    v_subrev_f32 v180, s6, v168
    v_subrev_f32 v181, s6, v169
    v_subrev_f32 v182, s6, v170
    v_subrev_f32 v183, s6, v171
    v_subrev_f32 v184, s6, v172
    v_add_f32 v186, v176, v177
    v_mul_f32 v187, v176, v176
    v_fmac_f32 v187, v177, v177
    v_add_f32 v186, v186, v178
    v_fmac_f32 v187, v178, v178
    v_add_f32 v186, v186, v179
    v_fmac_f32 v187, v179, v179
    v_add_f32 v186, v186, v180
    v_fmac_f32 v187, v180, v180
    v_add_f32 v186, v186, v181
    v_fmac_f32 v187, v181, v181
    v_add_f32 v186, v186, v182
    v_fmac_f32 v187, v182, v182
    v_add_f32 v186, v186, v183
    v_fmac_f32 v187, v183, v183
    v_add_f32 v186, v186, v184
    v_fmac_f32 v187, v184, v184
    s_nop 0
    v_add_f32_dpp v186, v186, v186 row_ror:8 row_mask:0xf bank_mask:0xf
    v_add_f32_dpp v187, v187, v187 row_ror:8 row_mask:0xf bank_mask:0xf
    s_nop 0
    v_add_f32_dpp v186, v186, v186 row_ror:4 row_mask:0xf bank_mask:0xf
    v_add_f32_dpp v187, v187, v187 row_ror:4 row_mask:0xf bank_mask:0xf
    s_nop 0
    v_add_f32_dpp v186, v186, v186 row_ror:2 row_mask:0xf bank_mask:0xf
    v_add_f32_dpp v187, v187, v187 row_ror:2 row_mask:0xf bank_mask:0xf
    s_nop 0
    v_add_f32_dpp v186, v186, v186 row_ror:1 row_mask:0xf bank_mask:0xf
    v_add_f32_dpp v187, v187, v187 row_ror:1 row_mask:0xf bank_mask:0xf
    v_mov_b32 v188, v186
    v_mov_b32 v189, v187
    s_nop 0
    v_permlane16_swap_b32 v186, v188
    v_permlane16_swap_b32 v187, v189
    v_add_f32 v186, v186, v188
    v_add_f32 v187, v187, v189
    v_mov_b32 v188, v186
    v_mov_b32 v189, v187
    s_nop 0
    v_permlane32_swap_b32 v186, v188
    v_permlane32_swap_b32 v187, v189
    v_add_f32 v186, v186, v188
    v_add_f32 v187, v187, v189
    v_mul_f32 v186, 0x3ae38e39, v186
    v_mul_f32 v187, 0x3ae38e39, v187
    v_fma_f32 v187, -v186, v186, v187
    v_add_f32 v186, s6, v186
    v_max_f32 v187, 0, v187
    v_cvt_pk_bf16_f32 v188, v186, v187
    v_lshlrev_b32 v190, 16, v188
    v_and_b32 v189, s7, v188
    v_add_f32 v189, 0x3727c5ac, v189
    v_cvt_pk_bf16_f32 v189, v189, v189
    v_and_b32 v189, s7, v189
    v_sqrt_f32 v189, v189
    s_nop 0
    v_cvt_pk_bf16_f32 v189, v189, v189
    v_and_b32 v189, s7, v189
    v_rcp_f32 v191, v189
    s_nop 0
    ds_write_b64 v199, v[190:191]
    v_xor_b32 v38, 96, v37
    s_add_u32 m0, s11, 3072
    s_add_u32 s6, s10, 98304
    buffer_load_dwordx4 v38, s[52:55], s6 offen nt lds
    s_waitcnt vmcnt(13)
    v_mfma_f32_16x16x32_bf16 v[144:147], v[72:75], v[216:219], 0
    v_mfma_f32_16x16x32_bf16 v[148:151], v[76:79], v[216:219], 0
    v_mfma_f32_16x16x32_bf16 v[152:155], v[192:195], v[216:219], 0
    v_xor_b32 v38, 128, v37
    s_add_u32 m0, s11, 4096
    s_add_u32 s6, s10, 131072
    buffer_load_dwordx4 v38, s[52:55], s6 offen nt lds
    s_waitcnt vmcnt(13)
    v_mfma_f32_16x16x32_bf16 v[144:147], v[80:83], v[220:223], v[144:147]
    v_mfma_f32_16x16x32_bf16 v[148:151], v[84:87], v[220:223], v[148:151]
    v_mfma_f32_16x16x32_bf16 v[152:155], v[192:195], v[220:223], v[152:155]
    v_xor_b32 v38, 160, v37
    s_add_u32 m0, s11, 5120
    s_add_u32 s6, s10, 163840
    buffer_load_dwordx4 v38, s[52:55], s6 offen nt lds
    s_waitcnt vmcnt(13)
    v_mfma_f32_16x16x32_bf16 v[144:147], v[88:91], v[224:227], v[144:147]
    v_mfma_f32_16x16x32_bf16 v[148:151], v[92:95], v[224:227], v[148:151]
    v_mfma_f32_16x16x32_bf16 v[152:155], v[192:195], v[224:227], v[152:155]
    v_xor_b32 v38, 192, v37
    s_add_u32 m0, s11, 6144
    s_add_u32 s6, s10, 196608
    buffer_load_dwordx4 v38, s[52:55], s6 offen nt lds
    s_waitcnt vmcnt(12)
    v_mfma_f32_16x16x32_bf16 v[144:147], v[96:99], v[228:231], v[144:147]
    v_mfma_f32_16x16x32_bf16 v[148:151], v[100:103], v[228:231], v[148:151]
    v_mfma_f32_16x16x32_bf16 v[152:155], v[192:195], v[228:231], v[152:155]
    s_mov_b64 exec, 1
    buffer_store_dwordx2 v[40:41], off, s[36:39], s27 sc1
    s_mov_b64 exec, -1
    v_xor_b32 v38, 224, v37
    s_add_u32 m0, s11, 7168
    s_add_u32 s6, s10, 229376
    buffer_load_dwordx4 v38, s[52:55], s6 offen nt lds
    s_waitcnt vmcnt(13)
    v_mfma_f32_16x16x32_bf16 v[144:147], v[104:107], v[232:235], v[144:147]
    v_mfma_f32_16x16x32_bf16 v[148:151], v[108:111], v[232:235], v[148:151]
    v_mfma_f32_16x16x32_bf16 v[152:155], v[192:195], v[232:235], v[152:155]
    s_waitcnt vmcnt(12)
    v_mfma_f32_16x16x32_bf16 v[144:147], v[112:115], v[236:239], v[144:147]
    v_mfma_f32_16x16x32_bf16 v[148:151], v[116:119], v[236:239], v[148:151]
    v_mfma_f32_16x16x32_bf16 v[152:155], v[192:195], v[236:239], v[152:155]
    s_waitcnt vmcnt(11)
    v_mfma_f32_16x16x32_bf16 v[144:147], v[120:123], v[240:243], v[144:147]
    v_mfma_f32_16x16x32_bf16 v[148:151], v[124:127], v[240:243], v[148:151]
    v_mfma_f32_16x16x32_bf16 v[152:155], v[192:195], v[240:243], v[152:155]
    s_waitcnt vmcnt(10)
    v_mfma_f32_16x16x32_bf16 v[144:147], v[128:131], v[244:247], v[144:147]
    v_mfma_f32_16x16x32_bf16 v[148:151], v[132:135], v[244:247], v[148:151]
    v_mfma_f32_16x16x32_bf16 v[152:155], v[192:195], v[244:247], v[152:155]
    s_waitcnt vmcnt(9)
    v_mfma_f32_16x16x32_bf16 v[144:147], v[136:139], v[248:251], v[144:147]
    v_mfma_f32_16x16x32_bf16 v[148:151], v[140:143], v[248:251], v[148:151]
    v_mfma_f32_16x16x32_bf16 v[152:155], v[192:195], v[248:251], v[152:155]
    s_nop 5
    ds_write_b128 v196, v[144:147] offset:0
    ds_write_b128 v196, v[148:151] offset:1024
    ds_write_b128 v196, v[152:155] offset:2048
    v_mov_b32 v110, s4
    v_mov_b32 v111, s5
    s_waitcnt lgkmcnt(0)
    s_barrier
    s_cmp_ge_u32 s3, 2
    s_cbranch_scc1 L_att_noqp
    ds_read_b128 v[72:75], v197 offset:0
    ds_read_b128 v[76:79], v197 offset:3072
    ds_read_b128 v[80:83], v197 offset:6144
    ds_read_b128 v[84:87], v197 offset:9216
    ds_read_b128 v[88:91], v198 offset:0
    ds_read_b128 v[92:95], v198 offset:3072
    ds_read_b128 v[96:99], v198 offset:6144
    ds_read_b128 v[100:103], v198 offset:9216
    ds_read_b64 v[104:105], v200
    s_waitcnt lgkmcnt(5)
    v_pk_add_f32 v[72:73], v[72:73], v[76:77]
    v_pk_add_f32 v[80:81], v[80:81], v[84:85]
    v_pk_add_f32 v[74:75], v[74:75], v[78:79]
    v_pk_add_f32 v[82:83], v[82:83], v[86:87]
    v_pk_add_f32 v[72:73], v[72:73], v[80:81]
    v_pk_add_f32 v[74:75], v[74:75], v[82:83]
    s_waitcnt lgkmcnt(1)
    v_pk_add_f32 v[88:89], v[88:89], v[92:93]
    v_pk_add_f32 v[96:97], v[96:97], v[100:101]
    v_pk_add_f32 v[90:91], v[90:91], v[94:95]
    v_pk_add_f32 v[98:99], v[98:99], v[102:103]
    v_pk_add_f32 v[88:89], v[88:89], v[96:97]
    v_pk_add_f32 v[90:91], v[90:91], v[98:99]
    s_waitcnt lgkmcnt(0)
    v_fma_f32 v72, -v104, v88, v72
    v_fma_f32 v73, -v104, v89, v73
    v_fma_f32 v74, -v104, v90, v74
    v_fma_f32 v75, -v104, v91, v75
    v_mul_f32 v72, v105, v72
    v_mul_f32 v73, v105, v73
    v_mul_f32 v74, v105, v74
    v_mul_f32 v75, v105, v75
    v_cvt_pk_bf16_f32 v108, v72, v73
    v_cvt_pk_bf16_f32 v109, v74, v75
    buffer_store_dwordx4 v[108:111], v5, s[36:39], s15 offen sc1
L_att_noqp:
    s_load_dwordx2 s[48:49], s[0:1], 40
    s_mov_b32 s50, 4718592
    s_mov_b32 s51, 0x00020000
    s_load_dwordx2 s[44:45], s[0:1], 72
    s_mov_b32 s46, 5308416
    s_mov_b32 s47, 0x00020000
    s_load_dwordx2 s[56:57], s[0:1], 80
    s_mov_b32 s58, 4608
    s_mov_b32 s59, 0x00020000
    v_mov_b32 v39, v5
    s_mov_b32 s32, s15
    v_mov_b32 v26, s36
    v_mov_b32 v27, s37
    v_mov_b32 v23, 0
    v_mov_b32 v28, 0
    s_cmp_ge_u32 s2, 200
    s_cbranch_scc1 L_prep_b
    s_load_dwordx4 s[96:99], s[0:1], 56
    s_sub_u32 s15, s2, 128
    s_mov_b32 s7, 0xffff0000
    v_sub_f32 v164, v164, v190
    v_sub_f32 v165, v165, v190
    v_sub_f32 v166, v166, v190
    v_sub_f32 v167, v167, v190
    v_sub_f32 v168, v168, v190
    v_sub_f32 v169, v169, v190
    v_sub_f32 v170, v170, v190
    v_sub_f32 v171, v171, v190
    v_sub_f32 v172, v172, v190
    v_cvt_pk_bf16_f32 v165, v164, v165
    v_cvt_pk_bf16_f32 v167, v166, v167
    v_cvt_pk_bf16_f32 v169, v168, v169
    v_cvt_pk_bf16_f32 v171, v170, v171
    v_cvt_pk_bf16_f32 v172, v172, v172
    v_lshlrev_b32 v164, 16, v165
    v_and_b32 v165, s7, v165
    v_lshlrev_b32 v166, 16, v167
    v_and_b32 v167, s7, v167
    v_lshlrev_b32 v168, 16, v169
    v_and_b32 v169, s7, v169
    v_lshlrev_b32 v170, 16, v171
    v_and_b32 v171, s7, v171
    v_and_b32 v172, s7, v172
    v_mul_f32 v164, v164, v191
    v_mul_f32 v165, v165, v191
    v_mul_f32 v166, v166, v191
    v_mul_f32 v167, v167, v191
    v_mul_f32 v168, v168, v191
    v_mul_f32 v169, v169, v191
    v_mul_f32 v170, v170, v191
    v_mul_f32 v171, v171, v191
    v_mul_f32 v172, v172, v191
    v_cvt_pk_bf16_f32 v176, v164, v164
    v_cvt_pk_bf16_f32 v177, v165, v165
    v_cvt_pk_bf16_f32 v178, v166, v166
    v_cvt_pk_bf16_f32 v179, v167, v167
    v_cvt_pk_bf16_f32 v180, v168, v168
    v_cvt_pk_bf16_f32 v181, v169, v169
    v_cvt_pk_bf16_f32 v182, v170, v170
    v_cvt_pk_bf16_f32 v183, v171, v171
    v_cvt_pk_bf16_f32 v184, v172, v172
    s_mul_i32 s6, s3, 2304
    s_add_u32 s6, s6, 73728
    v_lshl_add_u32 v188, v1, 5, s6
    v_lshl_add_u32 v189, v1, 2, s6
    ds_write_b128 v188, v[176:179]
    ds_write_b128 v188, v[180:183] offset:16
    ds_write_b32 v189, v184 offset:2048
    s_and_b32 s8, s15, 7
    s_mul_i32 s8, s8, 9
    s_lshr_b32 s6, s15, 3
    s_add_u32 s8, s8, s6
    s_add_u32 s9, s8, 1
    s_cmp_eq_u32 s9, 72
    s_cselect_b32 s9, 0, s9
    s_lshl_b32 s26, s8, 11
    s_add_u32 s26, s26, 1835008
    s_lshl_b32 s27, s9, 11
    s_add_u32 s27, s27, 1835008
    s_lshl_b32 s6, s3, 2
    v_add_u32 v28, s6, v14
    v_mul_u32_u24 v2, 331776, v28
    v_and_b32 v3, 7, v1
    v_lshl_add_u32 v2, v3, 4, v2
    v_cmp_gt_u32 vcc, 8, v15
    v_mov_b32 v3, s9
    v_mov_b32 v29, s8
    v_cndmask_b32 v3, v3, v29, vcc
    v_lshl_add_u32 v2, v3, 7, v2
    v_mov_b32 v3, 0
    s_waitcnt lgkmcnt(0)
    v_mov_b32 v26, s98
    v_mov_b32 v27, s99
    v_mov_b32 v29, s96
    v_mov_b32 v30, s97
    v_cndmask_b32 v26, v26, v29, vcc
    v_cndmask_b32 v27, v27, v30, vcc
    v_lshl_add_u64 v[26:27], v[2:3], 0, v[26:27]
    s_mov_b32 s30, 9216
    s_mov_b32 s31, 0
    s_sub_u32 s6, s9, 3
    s_and_b32 s6, s6, 7
    s_cmp_ge_u32 s6, 2
    s_cselect_b32 s17, 1, 0
    v_mul_u32_u24 v28, 144, v28
    v_bfe_u32 v2, v1, 3, 1
    v_mul_u32_u24 v2, 2304, v2
    v_add_u32 v28, v28, v2
    v_add_u32 v28, 73728, v28
    s_lshl_b32 s6, s3, 11
    s_add_u32 s6, s6, 83968
    v_lshl_add_u32 v23, v1, 4, s6
    v_bfe_u32 v2, v1, 2, 2
    v_lshlrev_b32 v2, 9, v2
    v_and_b32 v3, 1, v1
    v_lshl_add_u32 v2, v3, 8, v2
    v_bfe_u32 v3, v1, 1, 1
    v_lshl_add_u32 v2, v3, 6, v2
    v_lshl_add_u32 v2, v14, 4, v2
    v_add_u32 v24, 83968, v2
    s_branch L_prep_done
L_prep_b:
    s_cmp_ge_u32 s2, 232
    s_cbranch_scc1 L_prep_c
    s_sub_u32 s26, s2, 200
    s_and_b32 s8, s26, 7
    s_lshl_b32 s8, s8, 2
    s_lshr_b32 s6, s26, 3
    s_or_b32 s8, s8, s6
    s_add_u32 s26, s26, 24
    v_lshlrev_b32 v4, 4, v1
    v_lshlrev_b32 v5, 2, v1
    s_mul_i32 s6, s3, 6656
    s_lshl_b32 s27, s26, 6
    s_add_u32 s27, s27, s6
    s_add_u32 s27, s27, 16384
    s_mul_i32 s26, s26, 9216
    s_mul_i32 s6, s3, 2304
    s_add_u32 s26, s26, s6
    s_add_u32 s26, s26, 1048576
    v_lshrrev_b32 v2, 3, v1
    v_bfe_u32 v3, v1, 1, 2
    v_lshrrev_b32 v23, 4, v1
    v_xor_b32 v3, v3, v23
    s_and_b32 s6, s3, 1
    s_lshl_b32 s6, s6, 1
    v_xor_b32 v3, s6, v3
    v_mul_u32_u24 v2, 1152, v2
    v_lshl_add_u32 v2, v3, 5, v2
    v_and_b32 v3, 1, v1
    v_lshl_add_u32 v23, v3, 4, v2
    s_mul_i32 s29, s3, 9216
    s_mul_i32 s28, s8, 147456
    s_add_u32 s28, s28, s29
    v_lshrrev_b32 v2, 4, v1
    v_mul_u32_u24 v24, 9216, v2
    v_bfe_u32 v3, v1, 2, 2
    v_lshl_add_u32 v24, v3, 7, v24
    v_lshrrev_b32 v3, 1, v3
    v_and_b32 v2, 1, v2
    v_lshlrev_b32 v2, 1, v2
    v_xor_b32 v3, v3, v2
    v_xor_b32 v3, s3, v3
    v_lshl_add_u32 v24, v3, 5, v24
    v_and_b32 v3, 3, v1
    v_lshl_add_u32 v24, v3, 3, v24
    v_xor_b32 v25, 64, v24
    v_add_u32 v25, 512, v25
    s_branch L_prep_done
L_prep_c:
    s_sub_u32 s26, s2, 232
    s_mul_i32 s18, s26, 6144
    s_add_u32 s18, s18, 1835008
    s_add_u32 s19, s18, 4096
    s_mul_i32 s29, s3, 9216
    s_mul_i32 s20, s26, 221184
    s_add_u32 s20, s20, s29
    v_lshlrev_b32 v4, 4, v1
    v_lshlrev_b32 v5, 2, v1
    s_mul_i32 s6, s3, 6656
    s_lshl_b32 s27, s26, 6
    s_add_u32 s27, s27, s6
    s_add_u32 s27, s27, 16384
    s_mul_i32 s26, s26, 9216
    s_mul_i32 s6, s3, 2304
    s_add_u32 s26, s26, s6
    s_add_u32 s26, s26, 1048576
    v_lshrrev_b32 v2, 3, v1
    v_bfe_u32 v3, v1, 1, 2
    v_lshrrev_b32 v23, 4, v1
    v_xor_b32 v3, v3, v23
    s_and_b32 s6, s3, 1
    s_lshl_b32 s6, s6, 1
    v_xor_b32 v3, s6, v3
    v_mul_u32_u24 v2, 1152, v2
    v_lshl_add_u32 v2, v3, 5, v2
    v_and_b32 v3, 1, v1
    v_lshl_add_u32 v23, v3, 4, v2
    v_lshrrev_b32 v2, 4, v1
    v_mul_u32_u24 v24, 9216, v2
    v_bfe_u32 v3, v1, 2, 2
    v_lshl_add_u32 v24, v3, 7, v24
    v_lshrrev_b32 v3, 1, v3
    v_and_b32 v2, 1, v2
    v_lshlrev_b32 v2, 1, v2
    v_xor_b32 v3, v3, v2
    v_xor_b32 v3, s3, v3
    v_lshl_add_u32 v24, v3, 5, v24
    v_and_b32 v3, 3, v1
    v_lshl_add_u32 v24, v3, 3, v24
    v_xor_b32 v25, 64, v24
    v_add_u32 v25, 512, v25
    v_and_b32 v3, 3, v1
    v_cmp_eq_u32 vcc, 0, v3
    s_nop 1
    v_cndmask_b32 v10, 0, -1, vcc
    v_cmp_eq_u32 vcc, 1, v3
    s_nop 1
    v_cndmask_b32 v11, 0, -1, vcc
    v_cmp_eq_u32 vcc, 2, v3
    s_nop 1
    v_cndmask_b32 v12, 0, -1, vcc
    v_cmp_eq_u32 vcc, 3, v3
    s_nop 1
    v_cndmask_b32 v13, 0, -1, vcc
L_prep_done:
    s_waitcnt vmcnt(0)
    buffer_load_dwordx4 v[112:115], v20, s[36:39], s13 offen offset:0 sc1
    buffer_load_dwordx4 v[116:119], v20, s[36:39], s13 offen offset:1024 sc1
    ds_read_b128 a[0:3], v32 offset:0
    ds_read_b128 a[4:7], v33 offset:0
    ds_read_b128 a[8:11], v34 offset:0
    ds_read_b128 a[12:15], v35 offset:0
    ds_read_b128 a[16:19], v32 offset:256
    ds_read_b128 a[20:23], v33 offset:256
    ds_read_b128 a[24:27], v34 offset:256
    ds_read_b128 a[28:31], v35 offset:256
    s_mov_b32 s63, 0
    s_waitcnt vmcnt(0)
L_qp_p_40:
    v_cmp_ne_u64 vcc, s[4:5], v[114:115]
    v_cmp_ne_u64 s[6:7], s[4:5], v[118:119]
    s_or_b64 vcc, vcc, s[6:7]
    s_cbranch_scc0 L_qp_d_41
    buffer_load_dwordx4 v[112:115], v20, s[36:39], s13 offen offset:0 sc1
    buffer_load_dwordx4 v[116:119], v20, s[36:39], s13 offen offset:1024 sc1
    s_add_u32 s63, s63, 1
    s_cmp_lt_u32 s63, 20000
    s_waitcnt vmcnt(0)
    s_cbranch_scc1 L_qp_p_40
L_qp_d_41:
    ds_write_b64 v21, v[112:113] offset:0
    ds_write_b64 v21, v[116:117] offset:2176
    s_waitcnt lgkmcnt(0)
    s_barrier
    ds_read_b128 v[48:51], v22 offset:0
    ds_read_b128 v[52:55], v22 offset:64
    ds_read_b128 v[56:59], v22 offset:128
    ds_read_b128 v[60:63], v22 offset:192
    s_waitcnt lgkmcnt(3)
    v_mfma_f32_16x16x32_bf16 v[64:67], v[48:51], a[0:3], 0
    v_mfma_f32_16x16x32_bf16 v[68:71], v[48:51], a[16:19], 0
    s_waitcnt lgkmcnt(2)
    v_mfma_f32_16x16x32_bf16 v[64:67], v[52:55], a[4:7], v[64:67]
    v_mfma_f32_16x16x32_bf16 v[68:71], v[52:55], a[20:23], v[68:71]
    s_waitcnt lgkmcnt(1)
    v_mfma_f32_16x16x32_bf16 v[64:67], v[56:59], a[8:11], v[64:67]
    v_mfma_f32_16x16x32_bf16 v[68:71], v[56:59], a[24:27], v[68:71]
    s_waitcnt lgkmcnt(0)
    v_mfma_f32_16x16x32_bf16 v[64:67], v[60:63], a[12:15], v[64:67]
    v_mfma_f32_16x16x32_bf16 v[68:71], v[60:63], a[28:31], v[68:71]
    s_nop 6
    v_add_f32 v64, v64, v65
    v_add_f32 v66, v66, v67
    v_add_f32 v68, v68, v69
    v_add_f32 v70, v70, v71
    v_add_f32 v80, v64, v66
    v_add_f32 v81, v68, v70
    v_mul_f32 v80, 0x3e0293ee, v80
    v_mul_f32 v81, 0x3e0293ee, v81
    v_cvt_pk_bf16_f32 v84, v80, v81
    buffer_store_dword v84, v36, s[36:39], s16 offen sc1
    s_cmp_ge_u32 s2, 200
    s_cbranch_scc1 L_notffn
    global_load_dwordx4 v[32:35], v[26:27], off nt
    v_lshl_add_u64 v[26:27], v[26:27], 0, s[30:31]
    global_load_dwordx4 v[36:39], v[26:27], off nt
    v_lshl_add_u64 v[26:27], v[26:27], 0, s[30:31]
    ds_read_b128 v[176:179], v28 offset:0
    ds_read_b128 v[180:183], v28 offset:16
    ds_read_b128 v[184:187], v28 offset:32
    ds_read_b128 v[188:191], v28 offset:48
    ds_read_b128 v[192:195], v28 offset:64
    ds_read_b128 v[196:199], v28 offset:80
    ds_read_b128 v[200:203], v28 offset:96
    ds_read_b128 v[204:207], v28 offset:112
    ds_read_b128 v[208:211], v28 offset:128
    ds_read_b128 v[212:215], v28 offset:4608
    ds_read_b128 v[216:219], v28 offset:4624
    ds_read_b128 v[220:223], v28 offset:4640
    ds_read_b128 v[224:227], v28 offset:4656
    ds_read_b128 v[228:231], v28 offset:4672
    ds_read_b128 v[232:235], v28 offset:4688
    ds_read_b128 v[236:239], v28 offset:4704
    ds_read_b128 v[240:243], v28 offset:4720
    ds_read_b128 v[244:247], v28 offset:4736
    s_cmp_eq_u32 s17, 0
    s_cbranch_scc1 L_ffn_nw_42
    s_waitcnt vmcnt(1)
L_ffn_nw_42:
    global_load_dwordx4 v[40:43], v[26:27], off nt
    v_lshl_add_u64 v[26:27], v[26:27], 0, s[30:31]
    s_cmp_eq_u32 s17, 0
    s_cbranch_scc1 L_ffn_nw_43
    s_waitcnt vmcnt(1)
L_ffn_nw_43:
    global_load_dwordx4 v[44:47], v[26:27], off nt
    v_lshl_add_u64 v[26:27], v[26:27], 0, s[30:31]
    s_cmp_eq_u32 s17, 0
    s_cbranch_scc1 L_ffn_nw_44
    s_waitcnt vmcnt(1)
L_ffn_nw_44:
    global_load_dwordx4 v[48:51], v[26:27], off nt
    v_lshl_add_u64 v[26:27], v[26:27], 0, s[30:31]
    s_cmp_eq_u32 s17, 0
    s_cbranch_scc1 L_ffn_nw_45
    s_waitcnt vmcnt(1)
L_ffn_nw_45:
    global_load_dwordx4 v[52:55], v[26:27], off nt
    v_lshl_add_u64 v[26:27], v[26:27], 0, s[30:31]
    s_cmp_eq_u32 s17, 0
    s_cbranch_scc1 L_ffn_w_46
    s_waitcnt vmcnt(9)
L_ffn_w_46:
    global_load_dwordx4 v[56:59], v[26:27], off nt
    v_lshl_add_u64 v[26:27], v[26:27], 0, s[30:31]
    s_cbranch_scc1 L_ffn_w_47
    s_waitcnt vmcnt(9)
L_ffn_w_47:
    global_load_dwordx4 v[60:63], v[26:27], off nt
    v_lshl_add_u64 v[26:27], v[26:27], 0, s[30:31]
    s_cbranch_scc1 L_ffn_w_48
    s_waitcnt vmcnt(9)
L_ffn_w_48:
    global_load_dwordx4 v[64:67], v[26:27], off nt
    v_lshl_add_u64 v[26:27], v[26:27], 0, s[30:31]
    s_cbranch_scc1 L_ffn_w_49
    s_waitcnt vmcnt(9)
L_ffn_w_49:
    global_load_dwordx4 v[68:71], v[26:27], off nt
    v_lshl_add_u64 v[26:27], v[26:27], 0, s[30:31]
    s_cbranch_scc1 L_ffn_w_50
    s_waitcnt vmcnt(9)
L_ffn_w_50:
    global_load_dwordx4 v[72:75], v[26:27], off nt
    v_lshl_add_u64 v[26:27], v[26:27], 0, s[30:31]
    s_cbranch_scc1 L_ffn_w_51
    s_waitcnt vmcnt(9)
L_ffn_w_51:
    global_load_dwordx4 v[76:79], v[26:27], off nt
    v_lshl_add_u64 v[26:27], v[26:27], 0, s[30:31]
    s_cbranch_scc1 L_ffn_w_52
    s_waitcnt vmcnt(9)
L_ffn_w_52:
    global_load_dwordx4 v[80:83], v[26:27], off nt
    v_lshl_add_u64 v[26:27], v[26:27], 0, s[30:31]
    s_cbranch_scc1 L_ffn_w_53
    s_waitcnt vmcnt(9)
L_ffn_w_53:
    global_load_dwordx4 v[84:87], v[26:27], off nt
    v_lshl_add_u64 v[26:27], v[26:27], 0, s[30:31]
    s_waitcnt lgkmcnt(0)
    v_and_b32 v248, v176, v10
    v_and_b32 v249, v176, v11
    v_and_b32 v250, v176, v12
    v_and_b32 v251, v176, v13
    s_waitcnt vmcnt(13)
    s_nop 0
    v_mfma_f32_16x16x32_bf16 v[16:19], v[248:251], v[32:35], 0
    v_and_b32 v252, v212, v10
    v_and_b32 v253, v212, v11
    v_and_b32 v254, v212, v12
    v_and_b32 v255, v212, v13
    s_nop 1
    v_mfma_f32_16x16x32_bf16 v[28:31], v[252:255], v[32:35], 0
    s_cbranch_scc1 L_ffn_w_54
    s_waitcnt vmcnt(9)
L_ffn_w_54:
    global_load_dwordx4 v[88:91], v[26:27], off nt
    v_lshl_add_u64 v[26:27], v[26:27], 0, s[30:31]
    v_and_b32 v248, v177, v10
    v_and_b32 v249, v177, v11
    v_and_b32 v250, v177, v12
    v_and_b32 v251, v177, v13
    s_waitcnt vmcnt(13)
    s_nop 0
    v_mfma_f32_16x16x32_bf16 v[16:19], v[248:251], v[36:39], v[16:19]
    v_and_b32 v252, v213, v10
    v_and_b32 v253, v213, v11
    v_and_b32 v254, v213, v12
    v_and_b32 v255, v213, v13
    s_nop 1
    v_mfma_f32_16x16x32_bf16 v[28:31], v[252:255], v[36:39], v[28:31]
    s_cbranch_scc1 L_ffn_w_55
    s_waitcnt vmcnt(9)
L_ffn_w_55:
    global_load_dwordx4 v[92:95], v[26:27], off nt
    v_lshl_add_u64 v[26:27], v[26:27], 0, s[30:31]
    v_and_b32 v248, v178, v10
    v_and_b32 v249, v178, v11
    v_and_b32 v250, v178, v12
    v_and_b32 v251, v178, v13
    s_waitcnt vmcnt(13)
    s_nop 0
    v_mfma_f32_16x16x32_bf16 v[16:19], v[248:251], v[40:43], v[16:19]
    v_and_b32 v252, v214, v10
    v_and_b32 v253, v214, v11
    v_and_b32 v254, v214, v12
    v_and_b32 v255, v214, v13
    s_nop 1
    v_mfma_f32_16x16x32_bf16 v[28:31], v[252:255], v[40:43], v[28:31]
    s_cbranch_scc1 L_ffn_w_56
    s_waitcnt vmcnt(9)
L_ffn_w_56:
    global_load_dwordx4 v[96:99], v[26:27], off nt
    v_lshl_add_u64 v[26:27], v[26:27], 0, s[30:31]
    v_and_b32 v248, v179, v10
    v_and_b32 v249, v179, v11
    v_and_b32 v250, v179, v12
    v_and_b32 v251, v179, v13
    s_waitcnt vmcnt(13)
    s_nop 0
    v_mfma_f32_16x16x32_bf16 v[16:19], v[248:251], v[44:47], v[16:19]
    v_and_b32 v252, v215, v10
    v_and_b32 v253, v215, v11
    v_and_b32 v254, v215, v12
    v_and_b32 v255, v215, v13
    s_nop 1
    v_mfma_f32_16x16x32_bf16 v[28:31], v[252:255], v[44:47], v[28:31]
    s_cbranch_scc1 L_ffn_w_57
    s_waitcnt vmcnt(9)
L_ffn_w_57:
    global_load_dwordx4 v[100:103], v[26:27], off nt
    v_lshl_add_u64 v[26:27], v[26:27], 0, s[30:31]
    v_and_b32 v248, v180, v10
    v_and_b32 v249, v180, v11
    v_and_b32 v250, v180, v12
    v_and_b32 v251, v180, v13
    s_waitcnt vmcnt(13)
    s_nop 0
    v_mfma_f32_16x16x32_bf16 v[16:19], v[248:251], v[48:51], v[16:19]
    v_and_b32 v252, v216, v10
    v_and_b32 v253, v216, v11
    v_and_b32 v254, v216, v12
    v_and_b32 v255, v216, v13
    s_nop 1
    v_mfma_f32_16x16x32_bf16 v[28:31], v[252:255], v[48:51], v[28:31]
    s_cbranch_scc1 L_ffn_w_58
    s_waitcnt vmcnt(9)
L_ffn_w_58:
    global_load_dwordx4 v[104:107], v[26:27], off nt
    v_lshl_add_u64 v[26:27], v[26:27], 0, s[30:31]
    v_and_b32 v248, v181, v10
    v_and_b32 v249, v181, v11
    v_and_b32 v250, v181, v12
    v_and_b32 v251, v181, v13
    s_waitcnt vmcnt(13)
    s_nop 0
    v_mfma_f32_16x16x32_bf16 v[16:19], v[248:251], v[52:55], v[16:19]
    v_and_b32 v252, v217, v10
    v_and_b32 v253, v217, v11
    v_and_b32 v254, v217, v12
    v_and_b32 v255, v217, v13
    s_nop 1
    v_mfma_f32_16x16x32_bf16 v[28:31], v[252:255], v[52:55], v[28:31]
    s_cbranch_scc1 L_ffn_w_59
    s_waitcnt vmcnt(9)
L_ffn_w_59:
    global_load_dwordx4 v[108:111], v[26:27], off nt
    v_lshl_add_u64 v[26:27], v[26:27], 0, s[30:31]
    v_and_b32 v248, v182, v10
    v_and_b32 v249, v182, v11
    v_and_b32 v250, v182, v12
    v_and_b32 v251, v182, v13
    s_waitcnt vmcnt(13)
    s_nop 0
    v_mfma_f32_16x16x32_bf16 v[16:19], v[248:251], v[56:59], v[16:19]
    v_and_b32 v252, v218, v10
    v_and_b32 v253, v218, v11
    v_and_b32 v254, v218, v12
    v_and_b32 v255, v218, v13
    s_nop 1
    v_mfma_f32_16x16x32_bf16 v[28:31], v[252:255], v[56:59], v[28:31]
    s_cbranch_scc1 L_ffn_w_60
    s_waitcnt vmcnt(9)
L_ffn_w_60:
    global_load_dwordx4 v[112:115], v[26:27], off nt
    v_lshl_add_u64 v[26:27], v[26:27], 0, s[30:31]
    v_and_b32 v248, v183, v10
    v_and_b32 v249, v183, v11
    v_and_b32 v250, v183, v12
    v_and_b32 v251, v183, v13
    s_waitcnt vmcnt(13)
    s_nop 0
    v_mfma_f32_16x16x32_bf16 v[16:19], v[248:251], v[60:63], v[16:19]
    v_and_b32 v252, v219, v10
    v_and_b32 v253, v219, v11
    v_and_b32 v254, v219, v12
    v_and_b32 v255, v219, v13
    s_nop 1
    v_mfma_f32_16x16x32_bf16 v[28:31], v[252:255], v[60:63], v[28:31]
    s_cbranch_scc1 L_ffn_w_61
    s_waitcnt vmcnt(9)
L_ffn_w_61:
    global_load_dwordx4 v[116:119], v[26:27], off nt
    v_lshl_add_u64 v[26:27], v[26:27], 0, s[30:31]
    v_and_b32 v248, v184, v10
    v_and_b32 v249, v184, v11
    v_and_b32 v250, v184, v12
    v_and_b32 v251, v184, v13
    s_waitcnt vmcnt(13)
    s_nop 0
    v_mfma_f32_16x16x32_bf16 v[16:19], v[248:251], v[64:67], v[16:19]
    v_and_b32 v252, v220, v10
    v_and_b32 v253, v220, v11
    v_and_b32 v254, v220, v12
    v_and_b32 v255, v220, v13
    s_nop 1
    v_mfma_f32_16x16x32_bf16 v[28:31], v[252:255], v[64:67], v[28:31]
    s_cbranch_scc1 L_ffn_w_62
    s_waitcnt vmcnt(9)
L_ffn_w_62:
    global_load_dwordx4 v[120:123], v[26:27], off nt
    v_lshl_add_u64 v[26:27], v[26:27], 0, s[30:31]
    v_and_b32 v248, v185, v10
    v_and_b32 v249, v185, v11
    v_and_b32 v250, v185, v12
    v_and_b32 v251, v185, v13
    s_waitcnt vmcnt(13)
    s_nop 0
    v_mfma_f32_16x16x32_bf16 v[16:19], v[248:251], v[68:71], v[16:19]
    v_and_b32 v252, v221, v10
    v_and_b32 v253, v221, v11
    v_and_b32 v254, v221, v12
    v_and_b32 v255, v221, v13
    s_nop 1
    v_mfma_f32_16x16x32_bf16 v[28:31], v[252:255], v[68:71], v[28:31]
    s_cbranch_scc1 L_ffn_w_63
    s_waitcnt vmcnt(9)
L_ffn_w_63:
    global_load_dwordx4 v[124:127], v[26:27], off nt
    v_lshl_add_u64 v[26:27], v[26:27], 0, s[30:31]
    v_and_b32 v248, v186, v10
    v_and_b32 v249, v186, v11
    v_and_b32 v250, v186, v12
    v_and_b32 v251, v186, v13
    s_waitcnt vmcnt(13)
    s_nop 0
    v_mfma_f32_16x16x32_bf16 v[16:19], v[248:251], v[72:75], v[16:19]
    v_and_b32 v252, v222, v10
    v_and_b32 v253, v222, v11
    v_and_b32 v254, v222, v12
    v_and_b32 v255, v222, v13
    s_nop 1
    v_mfma_f32_16x16x32_bf16 v[28:31], v[252:255], v[72:75], v[28:31]
    s_cbranch_scc1 L_ffn_w_64
    s_waitcnt vmcnt(9)
L_ffn_w_64:
    global_load_dwordx4 v[128:131], v[26:27], off nt
    v_lshl_add_u64 v[26:27], v[26:27], 0, s[30:31]
    v_and_b32 v248, v187, v10
    v_and_b32 v249, v187, v11
    v_and_b32 v250, v187, v12
    v_and_b32 v251, v187, v13
    s_waitcnt vmcnt(13)
    s_nop 0
    v_mfma_f32_16x16x32_bf16 v[16:19], v[248:251], v[76:79], v[16:19]
    v_and_b32 v252, v223, v10
    v_and_b32 v253, v223, v11
    v_and_b32 v254, v223, v12
    v_and_b32 v255, v223, v13
    s_nop 1
    v_mfma_f32_16x16x32_bf16 v[28:31], v[252:255], v[76:79], v[28:31]
    s_cbranch_scc1 L_ffn_w_65
    s_waitcnt vmcnt(9)
L_ffn_w_65:
    global_load_dwordx4 v[132:135], v[26:27], off nt
    v_lshl_add_u64 v[26:27], v[26:27], 0, s[30:31]
    v_and_b32 v248, v188, v10
    v_and_b32 v249, v188, v11
    v_and_b32 v250, v188, v12
    v_and_b32 v251, v188, v13
    s_waitcnt vmcnt(13)
    s_nop 0
    v_mfma_f32_16x16x32_bf16 v[16:19], v[248:251], v[80:83], v[16:19]
    v_and_b32 v252, v224, v10
    v_and_b32 v253, v224, v11
    v_and_b32 v254, v224, v12
    v_and_b32 v255, v224, v13
    s_nop 1
    v_mfma_f32_16x16x32_bf16 v[28:31], v[252:255], v[80:83], v[28:31]
    s_cbranch_scc1 L_ffn_w_66
    s_waitcnt vmcnt(9)
L_ffn_w_66:
    global_load_dwordx4 v[136:139], v[26:27], off nt
    v_lshl_add_u64 v[26:27], v[26:27], 0, s[30:31]
    v_and_b32 v248, v189, v10
    v_and_b32 v249, v189, v11
    v_and_b32 v250, v189, v12
    v_and_b32 v251, v189, v13
    s_waitcnt vmcnt(13)
    s_nop 0
    v_mfma_f32_16x16x32_bf16 v[16:19], v[248:251], v[84:87], v[16:19]
    v_and_b32 v252, v225, v10
    v_and_b32 v253, v225, v11
    v_and_b32 v254, v225, v12
    v_and_b32 v255, v225, v13
    s_nop 1
    v_mfma_f32_16x16x32_bf16 v[28:31], v[252:255], v[84:87], v[28:31]
    s_cbranch_scc1 L_ffn_w_67
    s_waitcnt vmcnt(9)
L_ffn_w_67:
    global_load_dwordx4 v[140:143], v[26:27], off nt
    v_lshl_add_u64 v[26:27], v[26:27], 0, s[30:31]
    v_and_b32 v248, v190, v10
    v_and_b32 v249, v190, v11
    v_and_b32 v250, v190, v12
    v_and_b32 v251, v190, v13
    s_waitcnt vmcnt(13)
    s_nop 0
    v_mfma_f32_16x16x32_bf16 v[16:19], v[248:251], v[88:91], v[16:19]
    v_and_b32 v252, v226, v10
    v_and_b32 v253, v226, v11
    v_and_b32 v254, v226, v12
    v_and_b32 v255, v226, v13
    s_nop 1
    v_mfma_f32_16x16x32_bf16 v[28:31], v[252:255], v[88:91], v[28:31]
    s_cbranch_scc1 L_ffn_w_68
    s_waitcnt vmcnt(9)
L_ffn_w_68:
    global_load_dwordx4 v[144:147], v[26:27], off nt
    v_lshl_add_u64 v[26:27], v[26:27], 0, s[30:31]
    v_and_b32 v248, v191, v10
    v_and_b32 v249, v191, v11
    v_and_b32 v250, v191, v12
    v_and_b32 v251, v191, v13
    s_waitcnt vmcnt(13)
    s_nop 0
    v_mfma_f32_16x16x32_bf16 v[16:19], v[248:251], v[92:95], v[16:19]
    v_and_b32 v252, v227, v10
    v_and_b32 v253, v227, v11
    v_and_b32 v254, v227, v12
    v_and_b32 v255, v227, v13
    s_nop 1
    v_mfma_f32_16x16x32_bf16 v[28:31], v[252:255], v[92:95], v[28:31]
    s_cbranch_scc1 L_ffn_w_69
    s_waitcnt vmcnt(9)
L_ffn_w_69:
    global_load_dwordx4 v[148:151], v[26:27], off nt
    v_lshl_add_u64 v[26:27], v[26:27], 0, s[30:31]
    v_and_b32 v248, v192, v10
    v_and_b32 v249, v192, v11
    v_and_b32 v250, v192, v12
    v_and_b32 v251, v192, v13
    s_waitcnt vmcnt(13)
    s_nop 0
    v_mfma_f32_16x16x32_bf16 v[16:19], v[248:251], v[96:99], v[16:19]
    v_and_b32 v252, v228, v10
    v_and_b32 v253, v228, v11
    v_and_b32 v254, v228, v12
    v_and_b32 v255, v228, v13
    s_nop 1
    v_mfma_f32_16x16x32_bf16 v[28:31], v[252:255], v[96:99], v[28:31]
    s_cbranch_scc1 L_ffn_w_70
    s_waitcnt vmcnt(9)
L_ffn_w_70:
    global_load_dwordx4 v[152:155], v[26:27], off nt
    v_lshl_add_u64 v[26:27], v[26:27], 0, s[30:31]
    v_and_b32 v248, v193, v10
    v_and_b32 v249, v193, v11
    v_and_b32 v250, v193, v12
    v_and_b32 v251, v193, v13
    s_waitcnt vmcnt(13)
    s_nop 0
    v_mfma_f32_16x16x32_bf16 v[16:19], v[248:251], v[100:103], v[16:19]
    v_and_b32 v252, v229, v10
    v_and_b32 v253, v229, v11
    v_and_b32 v254, v229, v12
    v_and_b32 v255, v229, v13
    s_nop 1
    v_mfma_f32_16x16x32_bf16 v[28:31], v[252:255], v[100:103], v[28:31]
    s_cbranch_scc1 L_ffn_w_71
    s_waitcnt vmcnt(9)
L_ffn_w_71:
    global_load_dwordx4 v[156:159], v[26:27], off nt
    v_lshl_add_u64 v[26:27], v[26:27], 0, s[30:31]
    v_and_b32 v248, v194, v10
    v_and_b32 v249, v194, v11
    v_and_b32 v250, v194, v12
    v_and_b32 v251, v194, v13
    s_waitcnt vmcnt(13)
    s_nop 0
    v_mfma_f32_16x16x32_bf16 v[16:19], v[248:251], v[104:107], v[16:19]
    v_and_b32 v252, v230, v10
    v_and_b32 v253, v230, v11
    v_and_b32 v254, v230, v12
    v_and_b32 v255, v230, v13
    s_nop 1
    v_mfma_f32_16x16x32_bf16 v[28:31], v[252:255], v[104:107], v[28:31]
    s_cbranch_scc1 L_ffn_w_72
    s_waitcnt vmcnt(9)
L_ffn_w_72:
    global_load_dwordx4 v[160:163], v[26:27], off nt
    v_lshl_add_u64 v[26:27], v[26:27], 0, s[30:31]
    v_and_b32 v248, v195, v10
    v_and_b32 v249, v195, v11
    v_and_b32 v250, v195, v12
    v_and_b32 v251, v195, v13
    s_waitcnt vmcnt(13)
    s_nop 0
    v_mfma_f32_16x16x32_bf16 v[16:19], v[248:251], v[108:111], v[16:19]
    v_and_b32 v252, v231, v10
    v_and_b32 v253, v231, v11
    v_and_b32 v254, v231, v12
    v_and_b32 v255, v231, v13
    s_nop 1
    v_mfma_f32_16x16x32_bf16 v[28:31], v[252:255], v[108:111], v[28:31]
    s_cbranch_scc1 L_ffn_w_73
    s_waitcnt vmcnt(9)
L_ffn_w_73:
    global_load_dwordx4 v[164:167], v[26:27], off nt
    v_lshl_add_u64 v[26:27], v[26:27], 0, s[30:31]
    v_and_b32 v248, v196, v10
    v_and_b32 v249, v196, v11
    v_and_b32 v250, v196, v12
    v_and_b32 v251, v196, v13
    s_waitcnt vmcnt(13)
    s_nop 0
    v_mfma_f32_16x16x32_bf16 v[16:19], v[248:251], v[112:115], v[16:19]
    v_and_b32 v252, v232, v10
    v_and_b32 v253, v232, v11
    v_and_b32 v254, v232, v12
    v_and_b32 v255, v232, v13
    s_nop 1
    v_mfma_f32_16x16x32_bf16 v[28:31], v[252:255], v[112:115], v[28:31]
    s_cbranch_scc1 L_ffn_w_74
    s_waitcnt vmcnt(9)
L_ffn_w_74:
    global_load_dwordx4 v[168:171], v[26:27], off nt
    v_lshl_add_u64 v[26:27], v[26:27], 0, s[30:31]
    v_and_b32 v248, v197, v10
    v_and_b32 v249, v197, v11
    v_and_b32 v250, v197, v12
    v_and_b32 v251, v197, v13
    s_waitcnt vmcnt(13)
    s_nop 0
    v_mfma_f32_16x16x32_bf16 v[16:19], v[248:251], v[116:119], v[16:19]
    v_and_b32 v252, v233, v10
    v_and_b32 v253, v233, v11
    v_and_b32 v254, v233, v12
    v_and_b32 v255, v233, v13
    s_nop 1
    v_mfma_f32_16x16x32_bf16 v[28:31], v[252:255], v[116:119], v[28:31]
    s_cbranch_scc1 L_ffn_w_75
    s_waitcnt vmcnt(9)
L_ffn_w_75:
    global_load_dwordx4 v[172:175], v[26:27], off nt
    v_and_b32 v248, v198, v10
    v_and_b32 v249, v198, v11
    v_and_b32 v250, v198, v12
    v_and_b32 v251, v198, v13
    s_waitcnt vmcnt(13)
    s_nop 0
    v_mfma_f32_16x16x32_bf16 v[16:19], v[248:251], v[120:123], v[16:19]
    v_and_b32 v252, v234, v10
    v_and_b32 v253, v234, v11
    v_and_b32 v254, v234, v12
    v_and_b32 v255, v234, v13
    s_nop 1
    v_mfma_f32_16x16x32_bf16 v[28:31], v[252:255], v[120:123], v[28:31]
    v_and_b32 v248, v199, v10
    v_and_b32 v249, v199, v11
    v_and_b32 v250, v199, v12
    v_and_b32 v251, v199, v13
    s_waitcnt vmcnt(12)
    s_nop 0
    v_mfma_f32_16x16x32_bf16 v[16:19], v[248:251], v[124:127], v[16:19]
    v_and_b32 v252, v235, v10
    v_and_b32 v253, v235, v11
    v_and_b32 v254, v235, v12
    v_and_b32 v255, v235, v13
    s_nop 1
    v_mfma_f32_16x16x32_bf16 v[28:31], v[252:255], v[124:127], v[28:31]
    v_and_b32 v248, v200, v10
    v_and_b32 v249, v200, v11
    v_and_b32 v250, v200, v12
    v_and_b32 v251, v200, v13
    s_waitcnt vmcnt(11)
    s_nop 0
    v_mfma_f32_16x16x32_bf16 v[16:19], v[248:251], v[128:131], v[16:19]
    v_and_b32 v252, v236, v10
    v_and_b32 v253, v236, v11
    v_and_b32 v254, v236, v12
    v_and_b32 v255, v236, v13
    s_nop 1
    v_mfma_f32_16x16x32_bf16 v[28:31], v[252:255], v[128:131], v[28:31]
    v_and_b32 v248, v201, v10
    v_and_b32 v249, v201, v11
    v_and_b32 v250, v201, v12
    v_and_b32 v251, v201, v13
    s_waitcnt vmcnt(10)
    s_nop 0
    v_mfma_f32_16x16x32_bf16 v[16:19], v[248:251], v[132:135], v[16:19]
    v_and_b32 v252, v237, v10
    v_and_b32 v253, v237, v11
    v_and_b32 v254, v237, v12
    v_and_b32 v255, v237, v13
    s_nop 1
    v_mfma_f32_16x16x32_bf16 v[28:31], v[252:255], v[132:135], v[28:31]
    v_and_b32 v248, v202, v10
    v_and_b32 v249, v202, v11
    v_and_b32 v250, v202, v12
    v_and_b32 v251, v202, v13
    s_waitcnt vmcnt(9)
    s_nop 0
    v_mfma_f32_16x16x32_bf16 v[16:19], v[248:251], v[136:139], v[16:19]
    v_and_b32 v252, v238, v10
    v_and_b32 v253, v238, v11
    v_and_b32 v254, v238, v12
    v_and_b32 v255, v238, v13
    s_nop 1
    v_mfma_f32_16x16x32_bf16 v[28:31], v[252:255], v[136:139], v[28:31]
    v_and_b32 v248, v203, v10
    v_and_b32 v249, v203, v11
    v_and_b32 v250, v203, v12
    v_and_b32 v251, v203, v13
    s_waitcnt vmcnt(8)
    s_nop 0
    v_mfma_f32_16x16x32_bf16 v[16:19], v[248:251], v[140:143], v[16:19]
    v_and_b32 v252, v239, v10
    v_and_b32 v253, v239, v11
    v_and_b32 v254, v239, v12
    v_and_b32 v255, v239, v13
    s_nop 1
    v_mfma_f32_16x16x32_bf16 v[28:31], v[252:255], v[140:143], v[28:31]
    v_and_b32 v248, v204, v10
    v_and_b32 v249, v204, v11
    v_and_b32 v250, v204, v12
    v_and_b32 v251, v204, v13
    s_waitcnt vmcnt(7)
    s_nop 0
    v_mfma_f32_16x16x32_bf16 v[16:19], v[248:251], v[144:147], v[16:19]
    v_and_b32 v252, v240, v10
    v_and_b32 v253, v240, v11
    v_and_b32 v254, v240, v12
    v_and_b32 v255, v240, v13
    s_nop 1
    v_mfma_f32_16x16x32_bf16 v[28:31], v[252:255], v[144:147], v[28:31]
    v_and_b32 v248, v205, v10
    v_and_b32 v249, v205, v11
    v_and_b32 v250, v205, v12
    v_and_b32 v251, v205, v13
    s_waitcnt vmcnt(6)
    s_nop 0
    v_mfma_f32_16x16x32_bf16 v[16:19], v[248:251], v[148:151], v[16:19]
    v_and_b32 v252, v241, v10
    v_and_b32 v253, v241, v11
    v_and_b32 v254, v241, v12
    v_and_b32 v255, v241, v13
    s_nop 1
    v_mfma_f32_16x16x32_bf16 v[28:31], v[252:255], v[148:151], v[28:31]
    v_and_b32 v248, v206, v10
    v_and_b32 v249, v206, v11
    v_and_b32 v250, v206, v12
    v_and_b32 v251, v206, v13
    s_waitcnt vmcnt(5)
    s_nop 0
    v_mfma_f32_16x16x32_bf16 v[16:19], v[248:251], v[152:155], v[16:19]
    v_and_b32 v252, v242, v10
    v_and_b32 v253, v242, v11
    v_and_b32 v254, v242, v12
    v_and_b32 v255, v242, v13
    s_nop 1
    v_mfma_f32_16x16x32_bf16 v[28:31], v[252:255], v[152:155], v[28:31]
    v_and_b32 v248, v207, v10
    v_and_b32 v249, v207, v11
    v_and_b32 v250, v207, v12
    v_and_b32 v251, v207, v13
    s_waitcnt vmcnt(4)
    s_nop 0
    v_mfma_f32_16x16x32_bf16 v[16:19], v[248:251], v[156:159], v[16:19]
    v_and_b32 v252, v243, v10
    v_and_b32 v253, v243, v11
    v_and_b32 v254, v243, v12
    v_and_b32 v255, v243, v13
    s_nop 1
    v_mfma_f32_16x16x32_bf16 v[28:31], v[252:255], v[156:159], v[28:31]
    v_and_b32 v248, v208, v10
    v_and_b32 v249, v208, v11
    v_and_b32 v250, v208, v12
    v_and_b32 v251, v208, v13
    s_waitcnt vmcnt(3)
    s_nop 0
    v_mfma_f32_16x16x32_bf16 v[16:19], v[248:251], v[160:163], v[16:19]
    v_and_b32 v252, v244, v10
    v_and_b32 v253, v244, v11
    v_and_b32 v254, v244, v12
    v_and_b32 v255, v244, v13
    s_nop 1
    v_mfma_f32_16x16x32_bf16 v[28:31], v[252:255], v[160:163], v[28:31]
    v_and_b32 v248, v209, v10
    v_and_b32 v249, v209, v11
    v_and_b32 v250, v209, v12
    v_and_b32 v251, v209, v13
    s_waitcnt vmcnt(2)
    s_nop 0
    v_mfma_f32_16x16x32_bf16 v[16:19], v[248:251], v[164:167], v[16:19]
    v_and_b32 v252, v245, v10
    v_and_b32 v253, v245, v11
    v_and_b32 v254, v245, v12
    v_and_b32 v255, v245, v13
    s_nop 1
    v_mfma_f32_16x16x32_bf16 v[28:31], v[252:255], v[164:167], v[28:31]
    v_and_b32 v248, v210, v10
    v_and_b32 v249, v210, v11
    v_and_b32 v250, v210, v12
    v_and_b32 v251, v210, v13
    s_waitcnt vmcnt(1)
    s_nop 0
    v_mfma_f32_16x16x32_bf16 v[16:19], v[248:251], v[168:171], v[16:19]
    v_and_b32 v252, v246, v10
    v_and_b32 v253, v246, v11
    v_and_b32 v254, v246, v12
    v_and_b32 v255, v246, v13
    s_nop 1
    v_mfma_f32_16x16x32_bf16 v[28:31], v[252:255], v[168:171], v[28:31]
    v_and_b32 v248, v211, v10
    v_and_b32 v249, v211, v11
    v_and_b32 v250, v211, v12
    v_and_b32 v251, v211, v13
    s_waitcnt vmcnt(0)
    s_nop 0
    v_mfma_f32_16x16x32_bf16 v[16:19], v[248:251], v[172:175], v[16:19]
    v_and_b32 v252, v247, v10
    v_and_b32 v253, v247, v11
    v_and_b32 v254, v247, v12
    v_and_b32 v255, v247, v13
    s_nop 1
    v_mfma_f32_16x16x32_bf16 v[28:31], v[252:255], v[172:175], v[28:31]
L_ffn_skip:
    s_nop 0
    ds_write_b128 v23, v[16:19]
    s_nop 5
    ds_write_b128 v23, v[28:31] offset:1024
    v_lshlrev_b32 v4, 4, v1
    s_waitcnt lgkmcnt(0)
    s_barrier
    s_cmp_lg_u32 s3, 0
    s_cbranch_scc1 L_ffn_end
    ds_read_b128 v[32:35], v24 offset:0
    ds_read_b128 v[36:39], v24 offset:2048
    ds_read_b128 v[40:43], v24 offset:4096
    ds_read_b128 v[44:47], v24 offset:6144
    ds_read_b128 v[48:51], v24 offset:128
    ds_read_b128 v[52:55], v24 offset:2176
    ds_read_b128 v[56:59], v24 offset:4224
    ds_read_b128 v[60:63], v24 offset:6272
    s_mov_b32 s7, 0xffff0000
    s_waitcnt lgkmcnt(4)
    v_pk_add_f32 v[32:33], v[32:33], v[36:37]
    v_pk_add_f32 v[40:41], v[40:41], v[44:45]
    v_pk_add_f32 v[34:35], v[34:35], v[38:39]
    v_pk_add_f32 v[42:43], v[42:43], v[46:47]
    v_pk_add_f32 v[32:33], v[32:33], v[40:41]
    v_pk_add_f32 v[34:35], v[34:35], v[42:43]
    v_cvt_pk_bf16_f32 v36, v32, v33
    v_cvt_pk_bf16_f32 v37, v34, v35
    v_lshlrev_b32 v32, 16, v36
    v_and_b32 v33, s7, v36
    v_lshlrev_b32 v34, 16, v37
    v_and_b32 v35, s7, v37
    v_mul_f32 v36, 0xbfb8aa3b, v32
    v_mul_f32 v37, 0xbfb8aa3b, v33
    v_mul_f32 v38, 0xbfb8aa3b, v34
    v_mul_f32 v39, 0xbfb8aa3b, v35
    v_exp_f32 v36, v36
    v_exp_f32 v37, v37
    v_exp_f32 v38, v38
    v_exp_f32 v39, v39
    v_add_f32 v36, 1.0, v36
    v_add_f32 v37, 1.0, v37
    v_add_f32 v38, 1.0, v38
    v_add_f32 v39, 1.0, v39
    v_rcp_f32 v36, v36
    v_rcp_f32 v37, v37
    v_rcp_f32 v38, v38
    v_rcp_f32 v39, v39
    v_mul_f32 v32, v32, v36
    v_mul_f32 v33, v33, v37
    v_mul_f32 v34, v34, v38
    v_mul_f32 v35, v35, v39
    v_cvt_pk_bf16_f32 v36, v32, v33
    v_cvt_pk_bf16_f32 v37, v34, v35
    v_mov_b32 v38, s4
    v_mov_b32 v39, s5
    buffer_store_dwordx4 v[36:39], v4, s[36:39], s26 offen sc1
    s_waitcnt lgkmcnt(0)
    v_pk_add_f32 v[48:49], v[48:49], v[52:53]
    v_pk_add_f32 v[56:57], v[56:57], v[60:61]
    v_pk_add_f32 v[50:51], v[50:51], v[54:55]
    v_pk_add_f32 v[58:59], v[58:59], v[62:63]
    v_pk_add_f32 v[48:49], v[48:49], v[56:57]
    v_pk_add_f32 v[50:51], v[50:51], v[58:59]
    v_cvt_pk_bf16_f32 v52, v48, v49
    v_cvt_pk_bf16_f32 v53, v50, v51
    v_mov_b32 v54, s4
    v_mov_b32 v55, s5
    buffer_store_dwordx4 v[52:55], v4, s[36:39], s27 offen offset:1024 sc1
L_ffn_end:
    s_endpgm
L_notffn:
    s_cmp_ge_u32 s2, 232
    s_cbranch_scc1 L_fin
    s_add_u32 m0, s29, 0
    s_add_u32 s6, s28, 0
    buffer_load_dwordx4 v23, s[48:51], s6 offen nt lds
    s_add_u32 m0, s29, 1024
    s_add_u32 s6, s28, 128
    buffer_load_dwordx4 v23, s[48:51], s6 offen nt lds
    buffer_store_dwordx4 v[16:19], v4, s[36:39], s26 offen sc1
    buffer_store_dwordx4 v[16:19], v4, s[36:39], s26 offen offset:1024 sc1
    buffer_store_dword v16, v5, s[36:39], s26 offen offset:2048 sc1
    s_waitcnt vmcnt(1)
    s_add_u32 m0, s29, 2048
    s_add_u32 s6, s28, 256
    buffer_load_dwordx4 v23, s[48:51], s6 offen nt lds
    s_waitcnt vmcnt(1)
    s_add_u32 m0, s29, 3072
    s_add_u32 s6, s28, 384
    buffer_load_dwordx4 v23, s[48:51], s6 offen nt lds
    s_waitcnt vmcnt(1)
    s_add_u32 m0, s29, 4096
    s_add_u32 s6, s28, 512
    buffer_load_dwordx4 v23, s[48:51], s6 offen nt lds
    s_waitcnt vmcnt(1)
    s_add_u32 m0, s29, 5120
    s_add_u32 s6, s28, 640
    buffer_load_dwordx4 v23, s[48:51], s6 offen nt lds
    s_waitcnt vmcnt(1)
    s_add_u32 m0, s29, 6144
    s_add_u32 s6, s28, 768
    buffer_load_dwordx4 v23, s[48:51], s6 offen nt lds
    s_waitcnt vmcnt(1)
    s_add_u32 m0, s29, 7168
    s_add_u32 s6, s28, 896
    buffer_load_dwordx4 v23, s[48:51], s6 offen nt lds
    s_waitcnt vmcnt(7)
    s_add_u32 m0, s29, 8192
    s_add_u32 s6, s28, 1024
    buffer_load_dwordx4 v23, s[48:51], s6 offen nt lds
    s_waitcnt vmcnt(7)
    s_add_u32 m0, s29, 36864
    s_add_u32 s6, s28, 36864
    buffer_load_dwordx4 v23, s[48:51], s6 offen nt lds
    s_waitcnt vmcnt(7)
    s_add_u32 m0, s29, 37888
    s_add_u32 s6, s28, 36992
    buffer_load_dwordx4 v23, s[48:51], s6 offen nt lds
    s_waitcnt vmcnt(7)
    s_add_u32 m0, s29, 38912
    s_add_u32 s6, s28, 37120
    buffer_load_dwordx4 v23, s[48:51], s6 offen nt lds
    s_waitcnt vmcnt(7)
    s_add_u32 m0, s29, 39936
    s_add_u32 s6, s28, 37248
    buffer_load_dwordx4 v23, s[48:51], s6 offen nt lds
    s_waitcnt vmcnt(7)
    s_add_u32 m0, s29, 40960
    s_add_u32 s6, s28, 37376
    buffer_load_dwordx4 v23, s[48:51], s6 offen nt lds
    s_waitcnt vmcnt(7)
    s_add_u32 m0, s29, 41984
    s_add_u32 s6, s28, 37504
    buffer_load_dwordx4 v23, s[48:51], s6 offen nt lds
    s_waitcnt vmcnt(7)
    s_add_u32 m0, s29, 43008
    s_add_u32 s6, s28, 37632
    buffer_load_dwordx4 v23, s[48:51], s6 offen nt lds
    s_waitcnt vmcnt(7)
    s_add_u32 m0, s29, 44032
    s_add_u32 s6, s28, 37760
    buffer_load_dwordx4 v23, s[48:51], s6 offen nt lds
    s_waitcnt vmcnt(7)
    s_add_u32 m0, s29, 45056
    s_add_u32 s6, s28, 37888
    buffer_load_dwordx4 v23, s[48:51], s6 offen nt lds
    s_waitcnt vmcnt(16)
    v_mov_b32 v16, s4
    v_mov_b32 v17, s5
    v_mov_b32 v18, s4
    v_mov_b32 v19, s5
    s_mov_b64 exec, 1
    buffer_store_dwordx4 v[16:19], off, s[36:39], s27 sc1
    s_mov_b64 exec, -1
    s_waitcnt vmcnt(7)
    s_add_u32 m0, s29, 73728
    s_add_u32 s6, s28, 73728
    buffer_load_dwordx4 v23, s[48:51], s6 offen nt lds
    s_waitcnt vmcnt(7)
    s_add_u32 m0, s29, 74752
    s_add_u32 s6, s28, 73856
    buffer_load_dwordx4 v23, s[48:51], s6 offen nt lds
    s_waitcnt vmcnt(7)
    s_add_u32 m0, s29, 75776
    s_add_u32 s6, s28, 73984
    buffer_load_dwordx4 v23, s[48:51], s6 offen nt lds
    s_waitcnt vmcnt(7)
    s_add_u32 m0, s29, 76800
    s_add_u32 s6, s28, 74112
    buffer_load_dwordx4 v23, s[48:51], s6 offen nt lds
    s_waitcnt vmcnt(7)
    s_add_u32 m0, s29, 77824
    s_add_u32 s6, s28, 74240
    buffer_load_dwordx4 v23, s[48:51], s6 offen nt lds
    s_waitcnt vmcnt(7)
    s_add_u32 m0, s29, 78848
    s_add_u32 s6, s28, 74368
    buffer_load_dwordx4 v23, s[48:51], s6 offen nt lds
    s_waitcnt vmcnt(7)
    s_add_u32 m0, s29, 79872
    s_add_u32 s6, s28, 74496
    buffer_load_dwordx4 v23, s[48:51], s6 offen nt lds
    s_waitcnt vmcnt(7)
    s_add_u32 m0, s29, 80896
    s_add_u32 s6, s28, 74624
    buffer_load_dwordx4 v23, s[48:51], s6 offen nt lds
    s_waitcnt vmcnt(7)
    s_add_u32 m0, s29, 81920
    s_add_u32 s6, s28, 74752
    buffer_load_dwordx4 v23, s[48:51], s6 offen nt lds
    s_waitcnt vmcnt(7)
    s_add_u32 m0, s29, 110592
    s_add_u32 s6, s28, 110592
    buffer_load_dwordx4 v23, s[48:51], s6 offen nt lds
    s_waitcnt vmcnt(7)
    s_add_u32 m0, s29, 111616
    s_add_u32 s6, s28, 110720
    buffer_load_dwordx4 v23, s[48:51], s6 offen nt lds
    s_waitcnt vmcnt(7)
    s_add_u32 m0, s29, 112640
    s_add_u32 s6, s28, 110848
    buffer_load_dwordx4 v23, s[48:51], s6 offen nt lds
    s_waitcnt vmcnt(7)
    s_add_u32 m0, s29, 113664
    s_add_u32 s6, s28, 110976
    buffer_load_dwordx4 v23, s[48:51], s6 offen nt lds
    s_waitcnt vmcnt(7)
    s_add_u32 m0, s29, 114688
    s_add_u32 s6, s28, 111104
    buffer_load_dwordx4 v23, s[48:51], s6 offen nt lds
    s_waitcnt vmcnt(7)
    s_add_u32 m0, s29, 115712
    s_add_u32 s6, s28, 111232
    buffer_load_dwordx4 v23, s[48:51], s6 offen nt lds
    s_waitcnt vmcnt(7)
    s_add_u32 m0, s29, 116736
    s_add_u32 s6, s28, 111360
    buffer_load_dwordx4 v23, s[48:51], s6 offen nt lds
    s_waitcnt vmcnt(7)
    s_add_u32 m0, s29, 117760
    s_add_u32 s6, s28, 111488
    buffer_load_dwordx4 v23, s[48:51], s6 offen nt lds
    s_waitcnt vmcnt(7)
    s_add_u32 m0, s29, 118784
    s_add_u32 s6, s28, 111616
    buffer_load_dwordx4 v23, s[48:51], s6 offen nt lds
    s_lshl_b32 s13, s8, 13
    s_add_u32 s13, s13, 524288
    s_lshl_b32 s6, s8, 2
    s_add_u32 s6, s6, s3
    s_lshl_b32 s6, s6, 6
    s_add_u32 s6, s6, 49152
    buffer_load_dwordx4 v[40:43], off, s[36:39], s6 sc1
    s_getreg_b32 s10, hwreg(HW_REG_XCC_ID)
    s_waitcnt vmcnt(0)
    v_cmp_ne_u64 vcc, s[4:5], v[42:43]
    v_cmp_ne_u32 s[6:7], s10, v40
    s_or_b64 vcc, vcc, s[6:7]
    s_cselect_b32 s6, 0, 7340032
    s_xor_b32 s13, s13, s6
    buffer_load_dwordx4 v[112:115], v20, s[36:39], s13 offen offset:0 sc1
    buffer_load_dwordx4 v[116:119], v20, s[36:39], s13 offen offset:1024 sc1
    s_barrier
    ds_read_b64_tr_b16 a[0:1], v24 offset:0
    ds_read_b64_tr_b16 a[2:3], v25 offset:0
    ds_read_b64_tr_b16 a[4:5], v24 offset:1024
    ds_read_b64_tr_b16 a[6:7], v25 offset:1024
    ds_read_b64_tr_b16 a[8:9], v24 offset:2048
    ds_read_b64_tr_b16 a[10:11], v25 offset:2048
    ds_read_b64_tr_b16 a[12:13], v24 offset:3072
    ds_read_b64_tr_b16 a[14:15], v25 offset:3072
    ds_read_b64_tr_b16 a[16:17], v24 offset:4096
    ds_read_b64_tr_b16 a[18:19], v25 offset:4096
    ds_read_b64_tr_b16 a[20:21], v24 offset:5120
    ds_read_b64_tr_b16 a[22:23], v25 offset:5120
    ds_read_b64_tr_b16 a[24:25], v24 offset:6144
    ds_read_b64_tr_b16 a[26:27], v25 offset:6144
    ds_read_b64_tr_b16 a[28:29], v24 offset:7168
    ds_read_b64_tr_b16 a[30:31], v25 offset:7168
    ds_read_b64_tr_b16 a[32:33], v24 offset:8192
    ds_read_b64_tr_b16 a[34:35], v25 offset:8192
    ds_read_b64_tr_b16 a[36:37], v24 offset:36864
    ds_read_b64_tr_b16 a[38:39], v25 offset:36864
    ds_read_b64_tr_b16 a[40:41], v24 offset:37888
    ds_read_b64_tr_b16 a[42:43], v25 offset:37888
    ds_read_b64_tr_b16 a[44:45], v24 offset:38912
    ds_read_b64_tr_b16 a[46:47], v25 offset:38912
    ds_read_b64_tr_b16 a[48:49], v24 offset:39936
    ds_read_b64_tr_b16 a[50:51], v25 offset:39936
    ds_read_b64_tr_b16 a[52:53], v24 offset:40960
    ds_read_b64_tr_b16 a[54:55], v25 offset:40960
    ds_read_b64_tr_b16 a[56:57], v24 offset:41984
    ds_read_b64_tr_b16 a[58:59], v25 offset:41984
    ds_read_b64_tr_b16 a[60:61], v24 offset:43008
    ds_read_b64_tr_b16 a[62:63], v25 offset:43008
    ds_read_b64_tr_b16 a[64:65], v24 offset:44032
    ds_read_b64_tr_b16 a[66:67], v25 offset:44032
    ds_read_b64_tr_b16 a[68:69], v24 offset:45056
    ds_read_b64_tr_b16 a[70:71], v25 offset:45056
    v_add_u32 v24, 73728, v24
    v_add_u32 v25, 73728, v25
    ds_read_b64_tr_b16 a[72:73], v24 offset:0
    ds_read_b64_tr_b16 a[74:75], v25 offset:0
    ds_read_b64_tr_b16 a[76:77], v24 offset:1024
    ds_read_b64_tr_b16 a[78:79], v25 offset:1024
    ds_read_b64_tr_b16 a[80:81], v24 offset:2048
    ds_read_b64_tr_b16 a[82:83], v25 offset:2048
    ds_read_b64_tr_b16 a[84:85], v24 offset:3072
    ds_read_b64_tr_b16 a[86:87], v25 offset:3072
    ds_read_b64_tr_b16 a[88:89], v24 offset:4096
    ds_read_b64_tr_b16 a[90:91], v25 offset:4096
    ds_read_b64_tr_b16 a[92:93], v24 offset:5120
    ds_read_b64_tr_b16 a[94:95], v25 offset:5120
    ds_read_b64_tr_b16 a[96:97], v24 offset:6144
    ds_read_b64_tr_b16 a[98:99], v25 offset:6144
    ds_read_b64_tr_b16 a[100:101], v24 offset:7168
    ds_read_b64_tr_b16 a[102:103], v25 offset:7168
    ds_read_b64_tr_b16 a[104:105], v24 offset:8192
    ds_read_b64_tr_b16 a[106:107], v25 offset:8192
    ds_read_b64_tr_b16 a[108:109], v24 offset:36864
    ds_read_b64_tr_b16 a[110:111], v25 offset:36864
    ds_read_b64_tr_b16 a[112:113], v24 offset:37888
    ds_read_b64_tr_b16 a[114:115], v25 offset:37888
    ds_read_b64_tr_b16 a[116:117], v24 offset:38912
    ds_read_b64_tr_b16 a[118:119], v25 offset:38912
    ds_read_b64_tr_b16 a[120:121], v24 offset:39936
    ds_read_b64_tr_b16 a[122:123], v25 offset:39936
    ds_read_b64_tr_b16 a[124:125], v24 offset:40960
    ds_read_b64_tr_b16 a[126:127], v25 offset:40960
    ds_read_b64_tr_b16 a[128:129], v24 offset:41984
    ds_read_b64_tr_b16 a[130:131], v25 offset:41984
    ds_read_b64_tr_b16 a[132:133], v24 offset:43008
    ds_read_b64_tr_b16 a[134:135], v25 offset:43008
    ds_read_b64_tr_b16 a[136:137], v24 offset:44032
    ds_read_b64_tr_b16 a[138:139], v25 offset:44032
    ds_read_b64_tr_b16 a[140:141], v24 offset:45056
    ds_read_b64_tr_b16 a[142:143], v25 offset:45056
    s_mov_b32 s63, 0
    s_waitcnt vmcnt(0)
L_cx_p_76:
    v_cmp_ne_u64 vcc, s[4:5], v[114:115]
    v_cmp_ne_u64 s[6:7], s[4:5], v[118:119]
    s_or_b64 vcc, vcc, s[6:7]
    s_cbranch_scc0 L_cx_d_77
    buffer_load_dwordx4 v[112:115], v20, s[36:39], s13 offen offset:0 sc1
    buffer_load_dwordx4 v[116:119], v20, s[36:39], s13 offen offset:1024 sc1
    s_add_u32 s63, s63, 1
    s_cmp_lt_u32 s63, 20000
    s_waitcnt vmcnt(0)
    s_cbranch_scc1 L_cx_p_76
L_cx_d_77:
    ds_write_b64 v21, v[112:113] offset:0
    ds_write_b64 v21, v[116:117] offset:2176
    s_waitcnt lgkmcnt(0)
    s_barrier
    ds_read_b128 v[48:51], v22 offset:0
    ds_read_b128 v[52:55], v22 offset:64
    ds_read_b128 v[56:59], v22 offset:128
    ds_read_b128 v[60:63], v22 offset:192
    s_waitcnt lgkmcnt(0)
    v_mfma_f32_16x16x32_bf16 v[64:67], v[48:51], a[0:3], 0
    v_mfma_f32_16x16x32_bf16 v[68:71], v[48:51], a[4:7], 0
    v_mfma_f32_16x16x32_bf16 v[72:75], v[48:51], a[8:11], 0
    v_mfma_f32_16x16x32_bf16 v[76:79], v[48:51], a[12:15], 0
    v_mfma_f32_16x16x32_bf16 v[80:83], v[48:51], a[16:19], 0
    v_mfma_f32_16x16x32_bf16 v[84:87], v[48:51], a[20:23], 0
    v_mfma_f32_16x16x32_bf16 v[88:91], v[48:51], a[24:27], 0
    v_mfma_f32_16x16x32_bf16 v[92:95], v[48:51], a[28:31], 0
    v_mfma_f32_16x16x32_bf16 v[96:99], v[48:51], a[32:35], 0
    v_mfma_f32_16x16x32_bf16 v[64:67], v[52:55], a[36:39], v[64:67]
    v_mfma_f32_16x16x32_bf16 v[68:71], v[52:55], a[40:43], v[68:71]
    v_mfma_f32_16x16x32_bf16 v[72:75], v[52:55], a[44:47], v[72:75]
    v_mfma_f32_16x16x32_bf16 v[76:79], v[52:55], a[48:51], v[76:79]
    v_mfma_f32_16x16x32_bf16 v[80:83], v[52:55], a[52:55], v[80:83]
    v_mfma_f32_16x16x32_bf16 v[84:87], v[52:55], a[56:59], v[84:87]
    v_mfma_f32_16x16x32_bf16 v[88:91], v[52:55], a[60:63], v[88:91]
    v_mfma_f32_16x16x32_bf16 v[92:95], v[52:55], a[64:67], v[92:95]
    v_mfma_f32_16x16x32_bf16 v[96:99], v[52:55], a[68:71], v[96:99]
    v_mfma_f32_16x16x32_bf16 v[64:67], v[56:59], a[72:75], v[64:67]
    v_mfma_f32_16x16x32_bf16 v[68:71], v[56:59], a[76:79], v[68:71]
    v_mfma_f32_16x16x32_bf16 v[72:75], v[56:59], a[80:83], v[72:75]
    v_mfma_f32_16x16x32_bf16 v[76:79], v[56:59], a[84:87], v[76:79]
    v_mfma_f32_16x16x32_bf16 v[80:83], v[56:59], a[88:91], v[80:83]
    v_mfma_f32_16x16x32_bf16 v[84:87], v[56:59], a[92:95], v[84:87]
    v_mfma_f32_16x16x32_bf16 v[88:91], v[56:59], a[96:99], v[88:91]
    v_mfma_f32_16x16x32_bf16 v[92:95], v[56:59], a[100:103], v[92:95]
    v_mfma_f32_16x16x32_bf16 v[96:99], v[56:59], a[104:107], v[96:99]
    v_mfma_f32_16x16x32_bf16 v[64:67], v[60:63], a[108:111], v[64:67]
    v_mfma_f32_16x16x32_bf16 v[68:71], v[60:63], a[112:115], v[68:71]
    v_mfma_f32_16x16x32_bf16 v[72:75], v[60:63], a[116:119], v[72:75]
    v_mfma_f32_16x16x32_bf16 v[76:79], v[60:63], a[120:123], v[76:79]
    v_mfma_f32_16x16x32_bf16 v[80:83], v[60:63], a[124:127], v[80:83]
    v_mfma_f32_16x16x32_bf16 v[84:87], v[60:63], a[128:131], v[84:87]
    v_mfma_f32_16x16x32_bf16 v[88:91], v[60:63], a[132:135], v[88:91]
    v_mfma_f32_16x16x32_bf16 v[92:95], v[60:63], a[136:139], v[92:95]
    v_mfma_f32_16x16x32_bf16 v[96:99], v[60:63], a[140:143], v[96:99]
    v_add_f32 v64, v64, v65
    v_add_f32 v66, v66, v67
    v_add_f32 v68, v68, v69
    v_add_f32 v70, v70, v71
    v_add_f32 v72, v72, v73
    v_add_f32 v74, v74, v75
    v_add_f32 v76, v76, v77
    v_add_f32 v78, v78, v79
    v_add_f32 v100, v64, v66
    v_add_f32 v101, v68, v70
    v_add_f32 v102, v72, v74
    v_add_f32 v103, v76, v78
    buffer_store_dwordx4 v[100:103], v4, s[36:39], s26 offen sc1
    v_add_f32 v80, v80, v81
    v_add_f32 v82, v82, v83
    v_add_f32 v84, v84, v85
    v_add_f32 v86, v86, v87
    v_add_f32 v88, v88, v89
    v_add_f32 v90, v90, v91
    v_add_f32 v92, v92, v93
    v_add_f32 v94, v94, v95
    v_add_f32 v104, v80, v82
    v_add_f32 v105, v84, v86
    v_add_f32 v106, v88, v90
    v_add_f32 v107, v92, v94
    buffer_store_dwordx4 v[104:107], v4, s[36:39], s26 offen offset:1024 sc1
    v_add_f32 v96, v96, v97
    v_add_f32 v98, v98, v99
    v_add_f32 v108, v96, v98
    buffer_store_dword v108, v5, s[36:39], s26 offen offset:2048 sc1
    s_endpgm
L_fin:
    s_add_u32 m0, s29, 0
    s_add_u32 s6, s20, 0
    buffer_load_dwordx4 v23, s[44:47], s6 offen nt lds
    s_add_u32 m0, s29, 1024
    s_add_u32 s6, s20, 128
    buffer_load_dwordx4 v23, s[44:47], s6 offen nt lds
    s_add_u32 m0, s29, 2048
    s_add_u32 s6, s20, 256
    buffer_load_dwordx4 v23, s[44:47], s6 offen nt lds
    s_add_u32 m0, s29, 3072
    s_add_u32 s6, s20, 384
    buffer_load_dwordx4 v23, s[44:47], s6 offen nt lds
    s_add_u32 m0, s29, 4096
    s_add_u32 s6, s20, 512
    buffer_load_dwordx4 v23, s[44:47], s6 offen nt lds
    s_add_u32 m0, s29, 5120
    s_add_u32 s6, s20, 640
    buffer_load_dwordx4 v23, s[44:47], s6 offen nt lds
    s_add_u32 m0, s29, 6144
    s_add_u32 s6, s20, 768
    buffer_load_dwordx4 v23, s[44:47], s6 offen nt lds
    s_add_u32 m0, s29, 7168
    s_add_u32 s6, s20, 896
    buffer_load_dwordx4 v23, s[44:47], s6 offen nt lds
    s_add_u32 m0, s29, 8192
    s_add_u32 s6, s20, 1024
    buffer_load_dwordx4 v23, s[44:47], s6 offen nt lds
    buffer_store_dwordx4 v[16:19], v4, s[36:39], s26 offen sc1
    buffer_store_dwordx4 v[16:19], v4, s[36:39], s26 offen offset:1024 sc1
    buffer_store_dword v16, v5, s[36:39], s26 offen offset:2048 sc1
    s_add_u32 m0, s29, 36864
    s_add_u32 s6, s20, 36864
    buffer_load_dwordx4 v23, s[44:47], s6 offen nt lds
    s_add_u32 m0, s29, 37888
    s_add_u32 s6, s20, 36992
    buffer_load_dwordx4 v23, s[44:47], s6 offen nt lds
    s_add_u32 m0, s29, 38912
    s_add_u32 s6, s20, 37120
    buffer_load_dwordx4 v23, s[44:47], s6 offen nt lds
    s_add_u32 m0, s29, 39936
    s_add_u32 s6, s20, 37248
    buffer_load_dwordx4 v23, s[44:47], s6 offen nt lds
    s_add_u32 m0, s29, 40960
    s_add_u32 s6, s20, 37376
    buffer_load_dwordx4 v23, s[44:47], s6 offen nt lds
    s_add_u32 m0, s29, 41984
    s_add_u32 s6, s20, 37504
    buffer_load_dwordx4 v23, s[44:47], s6 offen nt lds
    s_add_u32 m0, s29, 43008
    s_add_u32 s6, s20, 37632
    buffer_load_dwordx4 v23, s[44:47], s6 offen nt lds
    s_add_u32 m0, s29, 44032
    s_add_u32 s6, s20, 37760
    buffer_load_dwordx4 v23, s[44:47], s6 offen nt lds
    s_add_u32 m0, s29, 45056
    s_add_u32 s6, s20, 37888
    buffer_load_dwordx4 v23, s[44:47], s6 offen nt lds
    s_add_u32 m0, s29, 73728
    s_add_u32 s6, s20, 73728
    buffer_load_dwordx4 v23, s[44:47], s6 offen nt lds
    s_add_u32 m0, s29, 74752
    s_add_u32 s6, s20, 73856
    buffer_load_dwordx4 v23, s[44:47], s6 offen nt lds
    s_add_u32 m0, s29, 75776
    s_add_u32 s6, s20, 73984
    buffer_load_dwordx4 v23, s[44:47], s6 offen nt lds
    s_add_u32 m0, s29, 76800
    s_add_u32 s6, s20, 74112
    buffer_load_dwordx4 v23, s[44:47], s6 offen nt lds
    s_add_u32 m0, s29, 77824
    s_add_u32 s6, s20, 74240
    buffer_load_dwordx4 v23, s[44:47], s6 offen nt lds
    s_add_u32 m0, s29, 78848
    s_add_u32 s6, s20, 74368
    buffer_load_dwordx4 v23, s[44:47], s6 offen nt lds
    s_add_u32 m0, s29, 79872
    s_add_u32 s6, s20, 74496
    buffer_load_dwordx4 v23, s[44:47], s6 offen nt lds
    s_add_u32 m0, s29, 80896
    s_add_u32 s6, s20, 74624
    buffer_load_dwordx4 v23, s[44:47], s6 offen nt lds
    s_add_u32 m0, s29, 81920
    s_add_u32 s6, s20, 74752
    buffer_load_dwordx4 v23, s[44:47], s6 offen nt lds
    s_waitcnt vmcnt(18)
    v_mov_b32 v16, s4
    v_mov_b32 v17, s5
    v_mov_b32 v18, s4
    v_mov_b32 v19, s5
    s_mov_b64 exec, 1
    buffer_store_dwordx4 v[16:19], off, s[36:39], s27 sc1
    s_mov_b64 exec, -1
    s_barrier
    ds_read_b64_tr_b16 a[0:1], v24 offset:0
    ds_read_b64_tr_b16 a[2:3], v25 offset:0
    ds_read_b64_tr_b16 a[4:5], v24 offset:1024
    ds_read_b64_tr_b16 a[6:7], v25 offset:1024
    ds_read_b64_tr_b16 a[8:9], v24 offset:2048
    ds_read_b64_tr_b16 a[10:11], v25 offset:2048
    ds_read_b64_tr_b16 a[12:13], v24 offset:3072
    ds_read_b64_tr_b16 a[14:15], v25 offset:3072
    ds_read_b64_tr_b16 a[16:17], v24 offset:4096
    ds_read_b64_tr_b16 a[18:19], v25 offset:4096
    ds_read_b64_tr_b16 a[20:21], v24 offset:5120
    ds_read_b64_tr_b16 a[22:23], v25 offset:5120
    ds_read_b64_tr_b16 a[24:25], v24 offset:6144
    ds_read_b64_tr_b16 a[26:27], v25 offset:6144
    ds_read_b64_tr_b16 a[28:29], v24 offset:7168
    ds_read_b64_tr_b16 a[30:31], v25 offset:7168
    ds_read_b64_tr_b16 a[32:33], v24 offset:8192
    ds_read_b64_tr_b16 a[34:35], v25 offset:8192
    s_add_u32 m0, s29, 110592
    s_add_u32 s6, s20, 110592
    buffer_load_dwordx4 v23, s[44:47], s6 offen nt lds
    s_add_u32 m0, s29, 111616
    s_add_u32 s6, s20, 110720
    buffer_load_dwordx4 v23, s[44:47], s6 offen nt lds
    s_add_u32 m0, s29, 112640
    s_add_u32 s6, s20, 110848
    buffer_load_dwordx4 v23, s[44:47], s6 offen nt lds
    s_add_u32 m0, s29, 113664
    s_add_u32 s6, s20, 110976
    buffer_load_dwordx4 v23, s[44:47], s6 offen nt lds
    s_add_u32 m0, s29, 114688
    s_add_u32 s6, s20, 111104
    buffer_load_dwordx4 v23, s[44:47], s6 offen nt lds
    s_add_u32 m0, s29, 115712
    s_add_u32 s6, s20, 111232
    buffer_load_dwordx4 v23, s[44:47], s6 offen nt lds
    s_add_u32 m0, s29, 116736
    s_add_u32 s6, s20, 111360
    buffer_load_dwordx4 v23, s[44:47], s6 offen nt lds
    s_add_u32 m0, s29, 117760
    s_add_u32 s6, s20, 111488
    buffer_load_dwordx4 v23, s[44:47], s6 offen nt lds
    s_add_u32 m0, s29, 118784
    s_add_u32 s6, s20, 111616
    buffer_load_dwordx4 v23, s[44:47], s6 offen nt lds
    s_waitcnt vmcnt(19) lgkmcnt(0)
    s_barrier
    ds_read_b64_tr_b16 a[36:37], v24 offset:36864
    ds_read_b64_tr_b16 a[38:39], v25 offset:36864
    ds_read_b64_tr_b16 a[40:41], v24 offset:37888
    ds_read_b64_tr_b16 a[42:43], v25 offset:37888
    ds_read_b64_tr_b16 a[44:45], v24 offset:38912
    ds_read_b64_tr_b16 a[46:47], v25 offset:38912
    ds_read_b64_tr_b16 a[48:49], v24 offset:39936
    ds_read_b64_tr_b16 a[50:51], v25 offset:39936
    ds_read_b64_tr_b16 a[52:53], v24 offset:40960
    ds_read_b64_tr_b16 a[54:55], v25 offset:40960
    ds_read_b64_tr_b16 a[56:57], v24 offset:41984
    ds_read_b64_tr_b16 a[58:59], v25 offset:41984
    ds_read_b64_tr_b16 a[60:61], v24 offset:43008
    ds_read_b64_tr_b16 a[62:63], v25 offset:43008
    ds_read_b64_tr_b16 a[64:65], v24 offset:44032
    ds_read_b64_tr_b16 a[66:67], v25 offset:44032
    ds_read_b64_tr_b16 a[68:69], v24 offset:45056
    ds_read_b64_tr_b16 a[70:71], v25 offset:45056
    s_add_u32 m0, s29, 0
    s_add_u32 s6, s20, 147456
    buffer_load_dwordx4 v23, s[44:47], s6 offen nt lds
    s_add_u32 m0, s29, 1024
    s_add_u32 s6, s20, 147584
    buffer_load_dwordx4 v23, s[44:47], s6 offen nt lds
    s_add_u32 m0, s29, 2048
    s_add_u32 s6, s20, 147712
    buffer_load_dwordx4 v23, s[44:47], s6 offen nt lds
    s_add_u32 m0, s29, 3072
    s_add_u32 s6, s20, 147840
    buffer_load_dwordx4 v23, s[44:47], s6 offen nt lds
    s_add_u32 m0, s29, 4096
    s_add_u32 s6, s20, 147968
    buffer_load_dwordx4 v23, s[44:47], s6 offen nt lds
    s_add_u32 m0, s29, 5120
    s_add_u32 s6, s20, 148096
    buffer_load_dwordx4 v23, s[44:47], s6 offen nt lds
    s_add_u32 m0, s29, 6144
    s_add_u32 s6, s20, 148224
    buffer_load_dwordx4 v23, s[44:47], s6 offen nt lds
    s_add_u32 m0, s29, 7168
    s_add_u32 s6, s20, 148352
    buffer_load_dwordx4 v23, s[44:47], s6 offen nt lds
    s_add_u32 m0, s29, 8192
    s_add_u32 s6, s20, 148480
    buffer_load_dwordx4 v23, s[44:47], s6 offen nt lds
    s_waitcnt vmcnt(19) lgkmcnt(0)
    s_barrier
    v_add_u32 v24, 73728, v24
    v_add_u32 v25, 73728, v25
    ds_read_b64_tr_b16 a[72:73], v24 offset:0
    ds_read_b64_tr_b16 a[74:75], v25 offset:0
    ds_read_b64_tr_b16 a[76:77], v24 offset:1024
    ds_read_b64_tr_b16 a[78:79], v25 offset:1024
    ds_read_b64_tr_b16 a[80:81], v24 offset:2048
    ds_read_b64_tr_b16 a[82:83], v25 offset:2048
    ds_read_b64_tr_b16 a[84:85], v24 offset:3072
    ds_read_b64_tr_b16 a[86:87], v25 offset:3072
    ds_read_b64_tr_b16 a[88:89], v24 offset:4096
    ds_read_b64_tr_b16 a[90:91], v25 offset:4096
    ds_read_b64_tr_b16 a[92:93], v24 offset:5120
    ds_read_b64_tr_b16 a[94:95], v25 offset:5120
    ds_read_b64_tr_b16 a[96:97], v24 offset:6144
    ds_read_b64_tr_b16 a[98:99], v25 offset:6144
    ds_read_b64_tr_b16 a[100:101], v24 offset:7168
    ds_read_b64_tr_b16 a[102:103], v25 offset:7168
    ds_read_b64_tr_b16 a[104:105], v24 offset:8192
    ds_read_b64_tr_b16 a[106:107], v25 offset:8192
    s_add_u32 m0, s29, 36864
    s_add_u32 s6, s20, 184320
    buffer_load_dwordx4 v23, s[44:47], s6 offen nt lds
    s_add_u32 m0, s29, 37888
    s_add_u32 s6, s20, 184448
    buffer_load_dwordx4 v23, s[44:47], s6 offen nt lds
    s_add_u32 m0, s29, 38912
    s_add_u32 s6, s20, 184576
    buffer_load_dwordx4 v23, s[44:47], s6 offen nt lds
    s_add_u32 m0, s29, 39936
    s_add_u32 s6, s20, 184704
    buffer_load_dwordx4 v23, s[44:47], s6 offen nt lds
    s_add_u32 m0, s29, 40960
    s_add_u32 s6, s20, 184832
    buffer_load_dwordx4 v23, s[44:47], s6 offen nt lds
    s_add_u32 m0, s29, 41984
    s_add_u32 s6, s20, 184960
    buffer_load_dwordx4 v23, s[44:47], s6 offen nt lds
    s_add_u32 m0, s29, 43008
    s_add_u32 s6, s20, 185088
    buffer_load_dwordx4 v23, s[44:47], s6 offen nt lds
    s_add_u32 m0, s29, 44032
    s_add_u32 s6, s20, 185216
    buffer_load_dwordx4 v23, s[44:47], s6 offen nt lds
    s_add_u32 m0, s29, 45056
    s_add_u32 s6, s20, 185344
    buffer_load_dwordx4 v23, s[44:47], s6 offen nt lds
    v_mov_b32 v64, 0
    v_mov_b32 v65, 0
    v_mov_b32 v66, 0
    v_mov_b32 v67, 0
    v_mov_b32 v68, 0
    v_mov_b32 v69, 0
    v_mov_b32 v70, 0
    v_mov_b32 v71, 0
    v_mov_b32 v72, 0
    v_mov_b32 v73, 0
    v_mov_b32 v74, 0
    v_mov_b32 v75, 0
    v_mov_b32 v76, 0
    v_mov_b32 v77, 0
    v_mov_b32 v78, 0
    v_mov_b32 v79, 0
    v_mov_b32 v80, 0
    v_mov_b32 v81, 0
    v_mov_b32 v82, 0
    v_mov_b32 v83, 0
    v_mov_b32 v84, 0
    v_mov_b32 v85, 0
    v_mov_b32 v86, 0
    v_mov_b32 v87, 0
    v_mov_b32 v88, 0
    v_mov_b32 v89, 0
    v_mov_b32 v90, 0
    v_mov_b32 v91, 0
    v_mov_b32 v92, 0
    v_mov_b32 v93, 0
    v_mov_b32 v94, 0
    v_mov_b32 v95, 0
    v_mov_b32 v96, 0
    v_mov_b32 v97, 0
    v_mov_b32 v98, 0
    v_mov_b32 v99, 0
    s_sub_u32 s8, s2, 232
    s_min_u32 s8, s8, 17
    s_lshr_b32 s6, s3, 1
    s_lshl_b32 s9, s8, 1
    s_add_u32 s9, s9, s6
    s_and_b32 s10, s3, 1
    s_mul_i32 s11, s9, 57
    s_lshr_b32 s11, s11, 9
    s_mul_i32 s6, s11, 9
    s_sub_u32 s12, s9, s6
    v_lshrrev_b32 v14, 4, v1
    v_and_b32 v15, 15, v1
    s_and_b32 s6, s12, 3
    s_mul_i32 s6, s6, 576
    s_lshr_b32 s7, s12, 2
    s_lshl_b32 s7, s7, 8
    s_add_u32 s6, s6, s7
    s_lshl_b32 s7, s11, 4
    s_add_u32 s6, s6, s7
    v_lshl_add_u32 v26, v14, 6, v15
    v_bfe_u32 v2, v1, 2, 2
    v_mul_u32_u24 v2, 576, v2
    v_and_b32 v3, 3, v1
    v_lshl_add_u32 v2, v3, 2, v2
    v_add_u32 v2, v2, v14
    s_cmp_eq_u32 s12, 8
    s_cselect_b64 vcc, -1, 0
    v_cndmask_b32 v26, v26, v2, vcc
    v_add_u32 v26, s6, v26
    v_lshlrev_b32 v26, 1, v26
    v_mul_u32_u24 v27, 9216, v14
    v_lshl_add_u32 v27, v15, 4, v27
    s_mul_i32 s13, s10, 36864
    s_lshl_b32 s6, s9, 8
    s_add_u32 s13, s13, s6
    s_add_u32 s13, s13, 1048576
    v_min_u32 v2, 27, v1
    v_lshrrev_b32 v3, 2, v2
    v_and_b32 v2, 3, v2
    v_lshl_add_u32 v2, v3, 3, v2
    v_lshlrev_b32 v28, 6, v2
    s_mul_i32 s14, s11, 6656
    s_lshl_b32 s6, s10, 8
    s_add_u32 s14, s14, s6
    s_add_u32 s14, s14, 16384
    buffer_load_ushort v29, v26, s[40:43], 0 offen
    buffer_load_dwordx4 v[32:35], v28, s[36:39], s14 offen sc1
    s_lshl_b32 s15, s8, 2
    s_add_u32 s15, s15, s3
    s_waitcnt vmcnt(11)
    buffer_load_dwordx4 v[144:147], v4, s[36:39], s18 offen offset:0 sc1
    buffer_load_dwordx4 v[148:151], v4, s[36:39], s18 offen offset:1024 sc1
    buffer_load_dwordx4 v[152:155], v4, s[36:39], s18 offen offset:2048 sc1
    buffer_load_dwordx4 v[156:159], v4, s[36:39], s18 offen offset:3072 sc1
    buffer_load_dwordx4 v[160:163], v4, s[36:39], s19 offen offset:0 sc1
    buffer_load_dwordx4 v[164:167], v4, s[36:39], s19 offen offset:1024 sc1
    s_barrier
    ds_read_b64_tr_b16 a[108:109], v24 offset:36864
    ds_read_b64_tr_b16 a[110:111], v25 offset:36864
    ds_read_b64_tr_b16 a[112:113], v24 offset:37888
    ds_read_b64_tr_b16 a[114:115], v25 offset:37888
    ds_read_b64_tr_b16 a[116:117], v24 offset:38912
    ds_read_b64_tr_b16 a[118:119], v25 offset:38912
    ds_read_b64_tr_b16 a[120:121], v24 offset:39936
    ds_read_b64_tr_b16 a[122:123], v25 offset:39936
    ds_read_b64_tr_b16 a[124:125], v24 offset:40960
    ds_read_b64_tr_b16 a[126:127], v25 offset:40960
    ds_read_b64_tr_b16 a[128:129], v24 offset:41984
    ds_read_b64_tr_b16 a[130:131], v25 offset:41984
    ds_read_b64_tr_b16 a[132:133], v24 offset:43008
    ds_read_b64_tr_b16 a[134:135], v25 offset:43008
    ds_read_b64_tr_b16 a[136:137], v24 offset:44032
    ds_read_b64_tr_b16 a[138:139], v25 offset:44032
    ds_read_b64_tr_b16 a[140:141], v24 offset:45056
    ds_read_b64_tr_b16 a[142:143], v25 offset:45056
    v_subrev_u32 v24, 73728, v24
    v_subrev_u32 v25, 73728, v25
    ds_read_b64_tr_b16 a[144:145], v24 offset:0
    ds_read_b64_tr_b16 a[146:147], v25 offset:0
    ds_read_b64_tr_b16 a[148:149], v24 offset:1024
    ds_read_b64_tr_b16 a[150:151], v25 offset:1024
    ds_read_b64_tr_b16 a[152:153], v24 offset:2048
    ds_read_b64_tr_b16 a[154:155], v25 offset:2048
    ds_read_b64_tr_b16 a[156:157], v24 offset:3072
    ds_read_b64_tr_b16 a[158:159], v25 offset:3072
    ds_read_b64_tr_b16 a[160:161], v24 offset:4096
    ds_read_b64_tr_b16 a[162:163], v25 offset:4096
    ds_read_b64_tr_b16 a[164:165], v24 offset:5120
    ds_read_b64_tr_b16 a[166:167], v25 offset:5120
    ds_read_b64_tr_b16 a[168:169], v24 offset:6144
    ds_read_b64_tr_b16 a[170:171], v25 offset:6144
    ds_read_b64_tr_b16 a[172:173], v24 offset:7168
    ds_read_b64_tr_b16 a[174:175], v25 offset:7168
    ds_read_b64_tr_b16 a[176:177], v24 offset:8192
    ds_read_b64_tr_b16 a[178:179], v25 offset:8192
    s_waitcnt vmcnt(8) lgkmcnt(0)
    s_barrier
    ds_read_b64_tr_b16 a[180:181], v24 offset:36864
    ds_read_b64_tr_b16 a[182:183], v25 offset:36864
    ds_read_b64_tr_b16 a[184:185], v24 offset:37888
    ds_read_b64_tr_b16 a[186:187], v25 offset:37888
    ds_read_b64_tr_b16 a[188:189], v24 offset:38912
    ds_read_b64_tr_b16 a[190:191], v25 offset:38912
    ds_read_b64_tr_b16 a[192:193], v24 offset:39936
    ds_read_b64_tr_b16 a[194:195], v25 offset:39936
    ds_read_b64_tr_b16 a[196:197], v24 offset:40960
    ds_read_b64_tr_b16 a[198:199], v25 offset:40960
    ds_read_b64_tr_b16 a[200:201], v24 offset:41984
    ds_read_b64_tr_b16 a[202:203], v25 offset:41984
    ds_read_b64_tr_b16 a[204:205], v24 offset:43008
    ds_read_b64_tr_b16 a[206:207], v25 offset:43008
    ds_read_b64_tr_b16 a[208:209], v24 offset:44032
    ds_read_b64_tr_b16 a[210:211], v25 offset:44032
    ds_read_b64_tr_b16 a[212:213], v24 offset:45056
    ds_read_b64_tr_b16 a[214:215], v25 offset:45056
    s_mov_b32 s63, 0
    s_waitcnt vmcnt(6)
L_nt_poll_78:
    v_cmp_ne_u64 vcc, s[4:5], v[34:35]
    s_cmp_eq_u64 vcc, 0
    s_cbranch_scc1 L_nt_done_79
    buffer_load_dwordx4 v[32:35], v28, s[36:39], s14 offen sc1
    s_add_u32 s63, s63, 1
    s_cmp_lt_u32 s63, 20000
    s_waitcnt vmcnt(0)
    s_cbranch_scc1 L_nt_poll_78
L_nt_done_79:
    s_mov_b32 s63, 0
    s_mov_b32 s62, 0
    s_waitcnt vmcnt(4)
    v_cmp_ne_u64 vcc, s[4:5], v[146:147]
    v_cmp_ne_u64 s[6:7], s[4:5], v[150:151]
    s_or_b64 vcc, vcc, s[6:7]
    s_cmp_eq_u64 vcc, 0
    s_cbranch_scc1 L_hx_ok_83
    buffer_load_dwordx4 v[144:147], v4, s[36:39], s18 offen offset:0 sc1
    buffer_load_dwordx4 v[148:151], v4, s[36:39], s18 offen offset:1024 sc1
    s_branch L_hx_s_82
L_hx_ok_83:
    s_bitset1_b32 s62, 0
    v_lshlrev_b32 v40, 16, v144
    v_and_b32 v41, 0xffff0000, v144
    v_lshlrev_b32 v42, 16, v145
    v_and_b32 v43, 0xffff0000, v145
    v_lshlrev_b32 v44, 16, v148
    v_and_b32 v45, 0xffff0000, v148
    v_lshlrev_b32 v46, 16, v149
    v_and_b32 v47, 0xffff0000, v149
    v_pk_mul_f32 v[40:41], v[40:41], v[44:45]
    v_pk_mul_f32 v[42:43], v[42:43], v[46:47]
    v_cvt_pk_bf16_f32 v48, v40, v41
    v_cvt_pk_bf16_f32 v49, v42, v43
    v_and_b32 v52, v48, v10
    v_and_b32 v53, v49, v10
    v_and_b32 v54, v48, v11
    v_and_b32 v55, v49, v11
    v_and_b32 v56, v48, v12
    v_and_b32 v57, v49, v12
    v_and_b32 v58, v48, v13
    v_and_b32 v59, v49, v13
    v_mfma_f32_16x16x32_bf16 v[64:67], v[52:55], a[0:3], v[64:67]
    v_mfma_f32_16x16x32_bf16 v[68:71], v[52:55], a[4:7], v[68:71]
    v_mfma_f32_16x16x32_bf16 v[72:75], v[52:55], a[8:11], v[72:75]
    v_mfma_f32_16x16x32_bf16 v[76:79], v[52:55], a[12:15], v[76:79]
    v_mfma_f32_16x16x32_bf16 v[80:83], v[52:55], a[16:19], v[80:83]
    v_mfma_f32_16x16x32_bf16 v[84:87], v[52:55], a[20:23], v[84:87]
    v_mfma_f32_16x16x32_bf16 v[88:91], v[52:55], a[24:27], v[88:91]
    v_mfma_f32_16x16x32_bf16 v[92:95], v[52:55], a[28:31], v[92:95]
    v_mfma_f32_16x16x32_bf16 v[96:99], v[52:55], a[32:35], v[96:99]
    v_mfma_f32_16x16x32_bf16 v[64:67], v[56:59], a[36:39], v[64:67]
    v_mfma_f32_16x16x32_bf16 v[68:71], v[56:59], a[40:43], v[68:71]
    v_mfma_f32_16x16x32_bf16 v[72:75], v[56:59], a[44:47], v[72:75]
    v_mfma_f32_16x16x32_bf16 v[76:79], v[56:59], a[48:51], v[76:79]
    v_mfma_f32_16x16x32_bf16 v[80:83], v[56:59], a[52:55], v[80:83]
    v_mfma_f32_16x16x32_bf16 v[84:87], v[56:59], a[56:59], v[84:87]
    v_mfma_f32_16x16x32_bf16 v[88:91], v[56:59], a[60:63], v[88:91]
    v_mfma_f32_16x16x32_bf16 v[92:95], v[56:59], a[64:67], v[92:95]
    v_mfma_f32_16x16x32_bf16 v[96:99], v[56:59], a[68:71], v[96:99]
L_hx_s_82:
    s_waitcnt vmcnt(2)
    v_cmp_ne_u64 vcc, s[4:5], v[154:155]
    v_cmp_ne_u64 s[6:7], s[4:5], v[158:159]
    s_or_b64 vcc, vcc, s[6:7]
    s_cmp_eq_u64 vcc, 0
    s_cbranch_scc1 L_hx_ok_85
    buffer_load_dwordx4 v[152:155], v4, s[36:39], s18 offen offset:2048 sc1
    buffer_load_dwordx4 v[156:159], v4, s[36:39], s18 offen offset:3072 sc1
    s_branch L_hx_s_84
L_hx_ok_85:
    s_bitset1_b32 s62, 1
    v_lshlrev_b32 v40, 16, v152
    v_and_b32 v41, 0xffff0000, v152
    v_lshlrev_b32 v42, 16, v153
    v_and_b32 v43, 0xffff0000, v153
    v_lshlrev_b32 v44, 16, v156
    v_and_b32 v45, 0xffff0000, v156
    v_lshlrev_b32 v46, 16, v157
    v_and_b32 v47, 0xffff0000, v157
    v_pk_mul_f32 v[40:41], v[40:41], v[44:45]
    v_pk_mul_f32 v[42:43], v[42:43], v[46:47]
    v_cvt_pk_bf16_f32 v48, v40, v41
    v_cvt_pk_bf16_f32 v49, v42, v43
    v_and_b32 v52, v48, v10
    v_and_b32 v53, v49, v10
    v_and_b32 v54, v48, v11
    v_and_b32 v55, v49, v11
    v_and_b32 v56, v48, v12
    v_and_b32 v57, v49, v12
    v_and_b32 v58, v48, v13
    v_and_b32 v59, v49, v13
    v_mfma_f32_16x16x32_bf16 v[64:67], v[52:55], a[72:75], v[64:67]
    v_mfma_f32_16x16x32_bf16 v[68:71], v[52:55], a[76:79], v[68:71]
    v_mfma_f32_16x16x32_bf16 v[72:75], v[52:55], a[80:83], v[72:75]
    v_mfma_f32_16x16x32_bf16 v[76:79], v[52:55], a[84:87], v[76:79]
    v_mfma_f32_16x16x32_bf16 v[80:83], v[52:55], a[88:91], v[80:83]
    v_mfma_f32_16x16x32_bf16 v[84:87], v[52:55], a[92:95], v[84:87]
    v_mfma_f32_16x16x32_bf16 v[88:91], v[52:55], a[96:99], v[88:91]
    v_mfma_f32_16x16x32_bf16 v[92:95], v[52:55], a[100:103], v[92:95]
    v_mfma_f32_16x16x32_bf16 v[96:99], v[52:55], a[104:107], v[96:99]
    v_mfma_f32_16x16x32_bf16 v[64:67], v[56:59], a[108:111], v[64:67]
    v_mfma_f32_16x16x32_bf16 v[68:71], v[56:59], a[112:115], v[68:71]
    v_mfma_f32_16x16x32_bf16 v[72:75], v[56:59], a[116:119], v[72:75]
    v_mfma_f32_16x16x32_bf16 v[76:79], v[56:59], a[120:123], v[76:79]
    v_mfma_f32_16x16x32_bf16 v[80:83], v[56:59], a[124:127], v[80:83]
    v_mfma_f32_16x16x32_bf16 v[84:87], v[56:59], a[128:131], v[84:87]
    v_mfma_f32_16x16x32_bf16 v[88:91], v[56:59], a[132:135], v[88:91]
    v_mfma_f32_16x16x32_bf16 v[92:95], v[56:59], a[136:139], v[92:95]
    v_mfma_f32_16x16x32_bf16 v[96:99], v[56:59], a[140:143], v[96:99]
L_hx_s_84:
    s_waitcnt vmcnt(0)
    v_cmp_ne_u64 vcc, s[4:5], v[162:163]
    v_cmp_ne_u64 s[6:7], s[4:5], v[166:167]
    s_or_b64 vcc, vcc, s[6:7]
    s_cmp_eq_u64 vcc, 0
    s_cbranch_scc1 L_hx_ok_87
    buffer_load_dwordx4 v[160:163], v4, s[36:39], s19 offen offset:0 sc1
    buffer_load_dwordx4 v[164:167], v4, s[36:39], s19 offen offset:1024 sc1
    s_branch L_hx_s_86
L_hx_ok_87:
    s_bitset1_b32 s62, 2
    v_lshlrev_b32 v40, 16, v160
    v_and_b32 v41, 0xffff0000, v160
    v_lshlrev_b32 v42, 16, v161
    v_and_b32 v43, 0xffff0000, v161
    v_lshlrev_b32 v44, 16, v164
    v_and_b32 v45, 0xffff0000, v164
    v_lshlrev_b32 v46, 16, v165
    v_and_b32 v47, 0xffff0000, v165
    v_pk_mul_f32 v[40:41], v[40:41], v[44:45]
    v_pk_mul_f32 v[42:43], v[42:43], v[46:47]
    v_cvt_pk_bf16_f32 v48, v40, v41
    v_cvt_pk_bf16_f32 v49, v42, v43
    v_and_b32 v52, v48, v10
    v_and_b32 v53, v49, v10
    v_and_b32 v54, v48, v11
    v_and_b32 v55, v49, v11
    v_and_b32 v56, v48, v12
    v_and_b32 v57, v49, v12
    v_and_b32 v58, v48, v13
    v_and_b32 v59, v49, v13
    s_waitcnt lgkmcnt(0)
    v_mfma_f32_16x16x32_bf16 v[64:67], v[52:55], a[144:147], v[64:67]
    v_mfma_f32_16x16x32_bf16 v[68:71], v[52:55], a[148:151], v[68:71]
    v_mfma_f32_16x16x32_bf16 v[72:75], v[52:55], a[152:155], v[72:75]
    v_mfma_f32_16x16x32_bf16 v[76:79], v[52:55], a[156:159], v[76:79]
    v_mfma_f32_16x16x32_bf16 v[80:83], v[52:55], a[160:163], v[80:83]
    v_mfma_f32_16x16x32_bf16 v[84:87], v[52:55], a[164:167], v[84:87]
    v_mfma_f32_16x16x32_bf16 v[88:91], v[52:55], a[168:171], v[88:91]
    v_mfma_f32_16x16x32_bf16 v[92:95], v[52:55], a[172:175], v[92:95]
    v_mfma_f32_16x16x32_bf16 v[96:99], v[52:55], a[176:179], v[96:99]
    v_mfma_f32_16x16x32_bf16 v[64:67], v[56:59], a[180:183], v[64:67]
    v_mfma_f32_16x16x32_bf16 v[68:71], v[56:59], a[184:187], v[68:71]
    v_mfma_f32_16x16x32_bf16 v[72:75], v[56:59], a[188:191], v[72:75]
    v_mfma_f32_16x16x32_bf16 v[76:79], v[56:59], a[192:195], v[76:79]
    v_mfma_f32_16x16x32_bf16 v[80:83], v[56:59], a[196:199], v[80:83]
    v_mfma_f32_16x16x32_bf16 v[84:87], v[56:59], a[200:203], v[84:87]
    v_mfma_f32_16x16x32_bf16 v[88:91], v[56:59], a[204:207], v[88:91]
    v_mfma_f32_16x16x32_bf16 v[92:95], v[56:59], a[208:211], v[92:95]
    v_mfma_f32_16x16x32_bf16 v[96:99], v[56:59], a[212:215], v[96:99]
L_hx_s_86:
    s_cmp_eq_u32 s62, 7
    s_cbranch_scc1 L_hx_done_81
L_hx_poll_80:
    s_waitcnt vmcnt(0)
    s_bitcmp1_b32 s62, 0
    s_cbranch_scc1 L_hx_s_88
    v_cmp_ne_u64 vcc, s[4:5], v[146:147]
    v_cmp_ne_u64 s[6:7], s[4:5], v[150:151]
    s_or_b64 vcc, vcc, s[6:7]
    s_cmp_eq_u64 vcc, 0
    s_cbranch_scc1 L_hx_ok_89
    buffer_load_dwordx4 v[144:147], v4, s[36:39], s18 offen offset:0 sc1
    buffer_load_dwordx4 v[148:151], v4, s[36:39], s18 offen offset:1024 sc1
    s_branch L_hx_s_88
L_hx_ok_89:
    s_bitset1_b32 s62, 0
    v_lshlrev_b32 v40, 16, v144
    v_and_b32 v41, 0xffff0000, v144
    v_lshlrev_b32 v42, 16, v145
    v_and_b32 v43, 0xffff0000, v145
    v_lshlrev_b32 v44, 16, v148
    v_and_b32 v45, 0xffff0000, v148
    v_lshlrev_b32 v46, 16, v149
    v_and_b32 v47, 0xffff0000, v149
    v_pk_mul_f32 v[40:41], v[40:41], v[44:45]
    v_pk_mul_f32 v[42:43], v[42:43], v[46:47]
    v_cvt_pk_bf16_f32 v48, v40, v41
    v_cvt_pk_bf16_f32 v49, v42, v43
    v_and_b32 v52, v48, v10
    v_and_b32 v53, v49, v10
    v_and_b32 v54, v48, v11
    v_and_b32 v55, v49, v11
    v_and_b32 v56, v48, v12
    v_and_b32 v57, v49, v12
    v_and_b32 v58, v48, v13
    v_and_b32 v59, v49, v13
    v_mfma_f32_16x16x32_bf16 v[64:67], v[52:55], a[0:3], v[64:67]
    v_mfma_f32_16x16x32_bf16 v[68:71], v[52:55], a[4:7], v[68:71]
    v_mfma_f32_16x16x32_bf16 v[72:75], v[52:55], a[8:11], v[72:75]
    v_mfma_f32_16x16x32_bf16 v[76:79], v[52:55], a[12:15], v[76:79]
    v_mfma_f32_16x16x32_bf16 v[80:83], v[52:55], a[16:19], v[80:83]
    v_mfma_f32_16x16x32_bf16 v[84:87], v[52:55], a[20:23], v[84:87]
    v_mfma_f32_16x16x32_bf16 v[88:91], v[52:55], a[24:27], v[88:91]
    v_mfma_f32_16x16x32_bf16 v[92:95], v[52:55], a[28:31], v[92:95]
    v_mfma_f32_16x16x32_bf16 v[96:99], v[52:55], a[32:35], v[96:99]
    v_mfma_f32_16x16x32_bf16 v[64:67], v[56:59], a[36:39], v[64:67]
    v_mfma_f32_16x16x32_bf16 v[68:71], v[56:59], a[40:43], v[68:71]
    v_mfma_f32_16x16x32_bf16 v[72:75], v[56:59], a[44:47], v[72:75]
    v_mfma_f32_16x16x32_bf16 v[76:79], v[56:59], a[48:51], v[76:79]
    v_mfma_f32_16x16x32_bf16 v[80:83], v[56:59], a[52:55], v[80:83]
    v_mfma_f32_16x16x32_bf16 v[84:87], v[56:59], a[56:59], v[84:87]
    v_mfma_f32_16x16x32_bf16 v[88:91], v[56:59], a[60:63], v[88:91]
    v_mfma_f32_16x16x32_bf16 v[92:95], v[56:59], a[64:67], v[92:95]
    v_mfma_f32_16x16x32_bf16 v[96:99], v[56:59], a[68:71], v[96:99]
L_hx_s_88:
    s_bitcmp1_b32 s62, 1
    s_cbranch_scc1 L_hx_s_90
    v_cmp_ne_u64 vcc, s[4:5], v[154:155]
    v_cmp_ne_u64 s[6:7], s[4:5], v[158:159]
    s_or_b64 vcc, vcc, s[6:7]
    s_cmp_eq_u64 vcc, 0
    s_cbranch_scc1 L_hx_ok_91
    buffer_load_dwordx4 v[152:155], v4, s[36:39], s18 offen offset:2048 sc1
    buffer_load_dwordx4 v[156:159], v4, s[36:39], s18 offen offset:3072 sc1
    s_branch L_hx_s_90
L_hx_ok_91:
    s_bitset1_b32 s62, 1
    v_lshlrev_b32 v40, 16, v152
    v_and_b32 v41, 0xffff0000, v152
    v_lshlrev_b32 v42, 16, v153
    v_and_b32 v43, 0xffff0000, v153
    v_lshlrev_b32 v44, 16, v156
    v_and_b32 v45, 0xffff0000, v156
    v_lshlrev_b32 v46, 16, v157
    v_and_b32 v47, 0xffff0000, v157
    v_pk_mul_f32 v[40:41], v[40:41], v[44:45]
    v_pk_mul_f32 v[42:43], v[42:43], v[46:47]
    v_cvt_pk_bf16_f32 v48, v40, v41
    v_cvt_pk_bf16_f32 v49, v42, v43
    v_and_b32 v52, v48, v10
    v_and_b32 v53, v49, v10
    v_and_b32 v54, v48, v11
    v_and_b32 v55, v49, v11
    v_and_b32 v56, v48, v12
    v_and_b32 v57, v49, v12
    v_and_b32 v58, v48, v13
    v_and_b32 v59, v49, v13
    v_mfma_f32_16x16x32_bf16 v[64:67], v[52:55], a[72:75], v[64:67]
    v_mfma_f32_16x16x32_bf16 v[68:71], v[52:55], a[76:79], v[68:71]
    v_mfma_f32_16x16x32_bf16 v[72:75], v[52:55], a[80:83], v[72:75]
    v_mfma_f32_16x16x32_bf16 v[76:79], v[52:55], a[84:87], v[76:79]
    v_mfma_f32_16x16x32_bf16 v[80:83], v[52:55], a[88:91], v[80:83]
    v_mfma_f32_16x16x32_bf16 v[84:87], v[52:55], a[92:95], v[84:87]
    v_mfma_f32_16x16x32_bf16 v[88:91], v[52:55], a[96:99], v[88:91]
    v_mfma_f32_16x16x32_bf16 v[92:95], v[52:55], a[100:103], v[92:95]
    v_mfma_f32_16x16x32_bf16 v[96:99], v[52:55], a[104:107], v[96:99]
    v_mfma_f32_16x16x32_bf16 v[64:67], v[56:59], a[108:111], v[64:67]
    v_mfma_f32_16x16x32_bf16 v[68:71], v[56:59], a[112:115], v[68:71]
    v_mfma_f32_16x16x32_bf16 v[72:75], v[56:59], a[116:119], v[72:75]
    v_mfma_f32_16x16x32_bf16 v[76:79], v[56:59], a[120:123], v[76:79]
    v_mfma_f32_16x16x32_bf16 v[80:83], v[56:59], a[124:127], v[80:83]
    v_mfma_f32_16x16x32_bf16 v[84:87], v[56:59], a[128:131], v[84:87]
    v_mfma_f32_16x16x32_bf16 v[88:91], v[56:59], a[132:135], v[88:91]
    v_mfma_f32_16x16x32_bf16 v[92:95], v[56:59], a[136:139], v[92:95]
    v_mfma_f32_16x16x32_bf16 v[96:99], v[56:59], a[140:143], v[96:99]
L_hx_s_90:
    s_bitcmp1_b32 s62, 2
    s_cbranch_scc1 L_hx_s_92
    v_cmp_ne_u64 vcc, s[4:5], v[162:163]
    v_cmp_ne_u64 s[6:7], s[4:5], v[166:167]
    s_or_b64 vcc, vcc, s[6:7]
    s_cmp_eq_u64 vcc, 0
    s_cbranch_scc1 L_hx_ok_93
    buffer_load_dwordx4 v[160:163], v4, s[36:39], s19 offen offset:0 sc1
    buffer_load_dwordx4 v[164:167], v4, s[36:39], s19 offen offset:1024 sc1
    s_branch L_hx_s_92
L_hx_ok_93:
    s_bitset1_b32 s62, 2
    v_lshlrev_b32 v40, 16, v160
    v_and_b32 v41, 0xffff0000, v160
    v_lshlrev_b32 v42, 16, v161
    v_and_b32 v43, 0xffff0000, v161
    v_lshlrev_b32 v44, 16, v164
    v_and_b32 v45, 0xffff0000, v164
    v_lshlrev_b32 v46, 16, v165
    v_and_b32 v47, 0xffff0000, v165
    v_pk_mul_f32 v[40:41], v[40:41], v[44:45]
    v_pk_mul_f32 v[42:43], v[42:43], v[46:47]
    v_cvt_pk_bf16_f32 v48, v40, v41
    v_cvt_pk_bf16_f32 v49, v42, v43
    v_and_b32 v52, v48, v10
    v_and_b32 v53, v49, v10
    v_and_b32 v54, v48, v11
    v_and_b32 v55, v49, v11
    v_and_b32 v56, v48, v12
    v_and_b32 v57, v49, v12
    v_and_b32 v58, v48, v13
    v_and_b32 v59, v49, v13
    s_waitcnt lgkmcnt(0)
    v_mfma_f32_16x16x32_bf16 v[64:67], v[52:55], a[144:147], v[64:67]
    v_mfma_f32_16x16x32_bf16 v[68:71], v[52:55], a[148:151], v[68:71]
    v_mfma_f32_16x16x32_bf16 v[72:75], v[52:55], a[152:155], v[72:75]
    v_mfma_f32_16x16x32_bf16 v[76:79], v[52:55], a[156:159], v[76:79]
    v_mfma_f32_16x16x32_bf16 v[80:83], v[52:55], a[160:163], v[80:83]
    v_mfma_f32_16x16x32_bf16 v[84:87], v[52:55], a[164:167], v[84:87]
    v_mfma_f32_16x16x32_bf16 v[88:91], v[52:55], a[168:171], v[88:91]
    v_mfma_f32_16x16x32_bf16 v[92:95], v[52:55], a[172:175], v[92:95]
    v_mfma_f32_16x16x32_bf16 v[96:99], v[52:55], a[176:179], v[96:99]
    v_mfma_f32_16x16x32_bf16 v[64:67], v[56:59], a[180:183], v[64:67]
    v_mfma_f32_16x16x32_bf16 v[68:71], v[56:59], a[184:187], v[68:71]
    v_mfma_f32_16x16x32_bf16 v[72:75], v[56:59], a[188:191], v[72:75]
    v_mfma_f32_16x16x32_bf16 v[76:79], v[56:59], a[192:195], v[76:79]
    v_mfma_f32_16x16x32_bf16 v[80:83], v[56:59], a[196:199], v[80:83]
    v_mfma_f32_16x16x32_bf16 v[84:87], v[56:59], a[200:203], v[84:87]
    v_mfma_f32_16x16x32_bf16 v[88:91], v[56:59], a[204:207], v[88:91]
    v_mfma_f32_16x16x32_bf16 v[92:95], v[56:59], a[208:211], v[92:95]
    v_mfma_f32_16x16x32_bf16 v[96:99], v[56:59], a[212:215], v[96:99]
L_hx_s_92:
    s_cmp_eq_u32 s62, 7
    s_cbranch_scc1 L_hx_done_81
    s_add_u32 s63, s63, 1
    s_cmp_lt_u32 s63, 20000
    s_cbranch_scc1 L_hx_poll_80
    s_waitcnt vmcnt(0)
L_hx_done_81:
    s_nop 7
    v_add_f32 v64, v64, v65
    v_add_f32 v66, v66, v67
    v_add_f32 v68, v68, v69
    v_add_f32 v70, v70, v71
    v_add_f32 v72, v72, v73
    v_add_f32 v74, v74, v75
    v_add_f32 v76, v76, v77
    v_add_f32 v78, v78, v79
    v_add_f32 v100, v64, v66
    v_add_f32 v101, v68, v70
    v_add_f32 v102, v72, v74
    v_add_f32 v103, v76, v78
    buffer_store_dwordx4 v[100:103], v4, s[36:39], s26 offen sc1
    v_add_f32 v80, v80, v81
    v_add_f32 v82, v82, v83
    v_add_f32 v84, v84, v85
    v_add_f32 v86, v86, v87
    v_add_f32 v88, v88, v89
    v_add_f32 v90, v90, v91
    v_add_f32 v92, v92, v93
    v_add_f32 v94, v94, v95
    v_add_f32 v104, v80, v82
    v_add_f32 v105, v84, v86
    v_add_f32 v106, v88, v90
    v_add_f32 v107, v92, v94
    buffer_store_dwordx4 v[104:107], v4, s[36:39], s26 offen offset:1024 sc1
    v_add_f32 v96, v96, v97
    v_add_f32 v98, v98, v99
    v_add_f32 v108, v96, v98
    buffer_store_dword v108, v5, s[36:39], s26 offen offset:2048 sc1
    s_cmp_ge_u32 s2, 250
    s_cbranch_scc1 L_fin_end
    v_mov_b32 v16, s4
    v_mov_b32 v17, s5
    s_add_u32 s6, s13, 0
    buffer_load_dwordx4 v[112:115], v27, s[36:39], s6 offen sc1
    s_add_u32 s6, s13, 73728
    buffer_load_dwordx4 v[116:119], v27, s[36:39], s6 offen sc1
    s_add_u32 s6, s13, 147456
    buffer_load_dwordx4 v[120:123], v27, s[36:39], s6 offen sc1
    s_add_u32 s6, s13, 221184
    buffer_load_dwordx4 v[124:127], v27, s[36:39], s6 offen sc1
    s_add_u32 s6, s13, 294912
    buffer_load_dwordx4 v[128:131], v27, s[36:39], s6 offen sc1
    s_add_u32 s6, s13, 368640
    buffer_load_dwordx4 v[132:135], v27, s[36:39], s6 offen sc1
    s_add_u32 s6, s13, 442368
    buffer_load_dwordx4 v[136:139], v27, s[36:39], s6 offen sc1
    s_mov_b32 s63, 0
    s_mov_b32 s62, 0
    s_waitcnt vmcnt(6)
    v_max3_u32 v2, v112, v113, v114
    v_max_u32 v2, v2, v115
    v_cmp_eq_u32 vcc, -1, v2
    s_cmp_eq_u64 vcc, 0
    s_cbranch_scc1 L_pa_ok_97
    s_add_u32 s6, s13, 0
    buffer_load_dwordx4 v[112:115], v27, s[36:39], s6 offen sc1
    s_branch L_pa_s_96
L_pa_ok_97:
    s_bitset1_b32 s62, 0
L_pa_s_96:
    s_waitcnt vmcnt(5)
    v_max3_u32 v2, v116, v117, v118
    v_max_u32 v2, v2, v119
    v_cmp_eq_u32 vcc, -1, v2
    s_cmp_eq_u64 vcc, 0
    s_cbranch_scc1 L_pa_ok_99
    s_add_u32 s6, s13, 73728
    buffer_load_dwordx4 v[116:119], v27, s[36:39], s6 offen sc1
    s_branch L_pa_s_98
L_pa_ok_99:
    s_bitset1_b32 s62, 1
L_pa_s_98:
    s_waitcnt vmcnt(4)
    v_max3_u32 v2, v120, v121, v122
    v_max_u32 v2, v2, v123
    v_cmp_eq_u32 vcc, -1, v2
    s_cmp_eq_u64 vcc, 0
    s_cbranch_scc1 L_pa_ok_101
    s_add_u32 s6, s13, 147456
    buffer_load_dwordx4 v[120:123], v27, s[36:39], s6 offen sc1
    s_branch L_pa_s_100
L_pa_ok_101:
    s_bitset1_b32 s62, 2
L_pa_s_100:
    s_waitcnt vmcnt(3)
    v_max3_u32 v2, v124, v125, v126
    v_max_u32 v2, v2, v127
    v_cmp_eq_u32 vcc, -1, v2
    s_cmp_eq_u64 vcc, 0
    s_cbranch_scc1 L_pa_ok_103
    s_add_u32 s6, s13, 221184
    buffer_load_dwordx4 v[124:127], v27, s[36:39], s6 offen sc1
    s_branch L_pa_s_102
L_pa_ok_103:
    s_bitset1_b32 s62, 3
L_pa_s_102:
    s_waitcnt vmcnt(2)
    v_max3_u32 v2, v128, v129, v130
    v_max_u32 v2, v2, v131
    v_cmp_eq_u32 vcc, -1, v2
    s_cmp_eq_u64 vcc, 0
    s_cbranch_scc1 L_pa_ok_105
    s_add_u32 s6, s13, 294912
    buffer_load_dwordx4 v[128:131], v27, s[36:39], s6 offen sc1
    s_branch L_pa_s_104
L_pa_ok_105:
    s_bitset1_b32 s62, 4
L_pa_s_104:
    s_waitcnt vmcnt(1)
    v_max3_u32 v2, v132, v133, v134
    v_max_u32 v2, v2, v135
    v_cmp_eq_u32 vcc, -1, v2
    s_cmp_eq_u64 vcc, 0
    s_cbranch_scc1 L_pa_ok_107
    s_add_u32 s6, s13, 368640
    buffer_load_dwordx4 v[132:135], v27, s[36:39], s6 offen sc1
    s_branch L_pa_s_106
L_pa_ok_107:
    s_bitset1_b32 s62, 5
L_pa_s_106:
    s_waitcnt vmcnt(0)
    v_max3_u32 v2, v136, v137, v138
    v_max_u32 v2, v2, v139
    v_cmp_eq_u32 vcc, -1, v2
    s_cmp_eq_u64 vcc, 0
    s_cbranch_scc1 L_pa_ok_109
    s_add_u32 s6, s13, 442368
    buffer_load_dwordx4 v[136:139], v27, s[36:39], s6 offen sc1
    s_branch L_pa_s_108
L_pa_ok_109:
    s_bitset1_b32 s62, 6
L_pa_s_108:
    s_cmp_eq_u32 s62, 127
    s_cbranch_scc1 L_pa_done_95
L_pa_poll_94:
    s_waitcnt vmcnt(0)
    s_bitcmp1_b32 s62, 0
    s_cbranch_scc1 L_pa_s_110
    v_max3_u32 v2, v112, v113, v114
    v_max_u32 v2, v2, v115
    v_cmp_eq_u32 vcc, -1, v2
    s_cmp_eq_u64 vcc, 0
    s_cbranch_scc1 L_pa_ok_111
    s_add_u32 s6, s13, 0
    buffer_load_dwordx4 v[112:115], v27, s[36:39], s6 offen sc1
    s_branch L_pa_s_110
L_pa_ok_111:
    s_bitset1_b32 s62, 0
L_pa_s_110:
    s_bitcmp1_b32 s62, 1
    s_cbranch_scc1 L_pa_s_112
    v_max3_u32 v2, v116, v117, v118
    v_max_u32 v2, v2, v119
    v_cmp_eq_u32 vcc, -1, v2
    s_cmp_eq_u64 vcc, 0
    s_cbranch_scc1 L_pa_ok_113
    s_add_u32 s6, s13, 73728
    buffer_load_dwordx4 v[116:119], v27, s[36:39], s6 offen sc1
    s_branch L_pa_s_112
L_pa_ok_113:
    s_bitset1_b32 s62, 1
L_pa_s_112:
    s_bitcmp1_b32 s62, 2
    s_cbranch_scc1 L_pa_s_114
    v_max3_u32 v2, v120, v121, v122
    v_max_u32 v2, v2, v123
    v_cmp_eq_u32 vcc, -1, v2
    s_cmp_eq_u64 vcc, 0
    s_cbranch_scc1 L_pa_ok_115
    s_add_u32 s6, s13, 147456
    buffer_load_dwordx4 v[120:123], v27, s[36:39], s6 offen sc1
    s_branch L_pa_s_114
L_pa_ok_115:
    s_bitset1_b32 s62, 2
L_pa_s_114:
    s_bitcmp1_b32 s62, 3
    s_cbranch_scc1 L_pa_s_116
    v_max3_u32 v2, v124, v125, v126
    v_max_u32 v2, v2, v127
    v_cmp_eq_u32 vcc, -1, v2
    s_cmp_eq_u64 vcc, 0
    s_cbranch_scc1 L_pa_ok_117
    s_add_u32 s6, s13, 221184
    buffer_load_dwordx4 v[124:127], v27, s[36:39], s6 offen sc1
    s_branch L_pa_s_116
L_pa_ok_117:
    s_bitset1_b32 s62, 3
L_pa_s_116:
    s_bitcmp1_b32 s62, 4
    s_cbranch_scc1 L_pa_s_118
    v_max3_u32 v2, v128, v129, v130
    v_max_u32 v2, v2, v131
    v_cmp_eq_u32 vcc, -1, v2
    s_cmp_eq_u64 vcc, 0
    s_cbranch_scc1 L_pa_ok_119
    s_add_u32 s6, s13, 294912
    buffer_load_dwordx4 v[128:131], v27, s[36:39], s6 offen sc1
    s_branch L_pa_s_118
L_pa_ok_119:
    s_bitset1_b32 s62, 4
L_pa_s_118:
    s_bitcmp1_b32 s62, 5
    s_cbranch_scc1 L_pa_s_120
    v_max3_u32 v2, v132, v133, v134
    v_max_u32 v2, v2, v135
    v_cmp_eq_u32 vcc, -1, v2
    s_cmp_eq_u64 vcc, 0
    s_cbranch_scc1 L_pa_ok_121
    s_add_u32 s6, s13, 368640
    buffer_load_dwordx4 v[132:135], v27, s[36:39], s6 offen sc1
    s_branch L_pa_s_120
L_pa_ok_121:
    s_bitset1_b32 s62, 5
L_pa_s_120:
    s_bitcmp1_b32 s62, 6
    s_cbranch_scc1 L_pa_s_122
    v_max3_u32 v2, v136, v137, v138
    v_max_u32 v2, v2, v139
    v_cmp_eq_u32 vcc, -1, v2
    s_cmp_eq_u64 vcc, 0
    s_cbranch_scc1 L_pa_ok_123
    s_add_u32 s6, s13, 442368
    buffer_load_dwordx4 v[136:139], v27, s[36:39], s6 offen sc1
    s_branch L_pa_s_122
L_pa_ok_123:
    s_bitset1_b32 s62, 6
L_pa_s_122:
    s_cmp_eq_u32 s62, 127
    s_cbranch_scc1 L_pa_done_95
    s_add_u32 s63, s63, 1
    s_cmp_lt_u32 s63, 20000
    s_cbranch_scc1 L_pa_poll_94
    s_waitcnt vmcnt(0)
L_pa_done_95:
    v_pk_add_f32 v[112:113], v[112:113], v[136:137]
    v_pk_add_f32 v[114:115], v[114:115], v[138:139]
    v_pk_add_f32 v[116:117], v[116:117], v[132:133]
    v_pk_add_f32 v[118:119], v[118:119], v[134:135]
    v_pk_add_f32 v[120:121], v[120:121], v[128:129]
    v_pk_add_f32 v[122:123], v[122:123], v[130:131]
    v_pk_add_f32 v[112:113], v[112:113], v[124:125]
    v_pk_add_f32 v[114:115], v[114:115], v[126:127]
    v_pk_add_f32 v[116:117], v[116:117], v[120:121]
    v_pk_add_f32 v[118:119], v[118:119], v[122:123]
    v_pk_add_f32 v[112:113], v[112:113], v[116:117]
    v_pk_add_f32 v[114:115], v[114:115], v[118:119]
    s_nop 1
    v_permlane32_swap_b32 v112, v114
    v_permlane32_swap_b32 v113, v115
    v_add_f32 v112, v112, v114
    v_add_f32 v113, v113, v115
    s_nop 1
    v_permlane16_swap_b32 v112, v113
    v_add_f32 v112, v112, v113
    s_lshr_b32 s6, s3, 1
    s_lshl_b32 s6, s6, 8
    s_add_u32 s6, s6, 155648
    v_lshl_add_u32 v2, v1, 2, s6
    s_cmp_eq_u32 s10, 0
    s_cbranch_scc1 L_fin_even
    ds_write_b32 v2, v112
    s_waitcnt lgkmcnt(0)
    s_barrier
    s_cmp_lg_u32 s15, 1
    s_cbranch_scc1 L_fin_end
    s_mov_b64 exec, 1
    buffer_store_dwordx2 v[16:17], off, s[36:39], 0 sc1
    s_branch L_fin_end
L_fin_even:
    v_lshlrev_b32 v29, 16, v29
    v_add_f32 v112, v112, v29
    s_barrier
    ds_read_b32 v3, v2
    s_waitcnt lgkmcnt(0)
    v_add_f32 v112, v112, v3
    v_cvt_pk_bf16_f32 v112, v112, v112
    buffer_store_short v112, v26, s[56:59], 0 offen
L_fin_end:
    s_endpgm
L_end:
    s_endpgm
L_codeend:
.section .rodata,"a"
.p2align 6
.amdhsa_kernel parallel_sum__compressed_kv_cla__glu_gated_swiglu__decode_kernel
  .amdhsa_next_free_vgpr 512
  .amdhsa_next_free_sgpr 102
  .amdhsa_accum_offset 256
  .amdhsa_group_segment_fixed_size 0
  .amdhsa_kernarg_size 104
  .amdhsa_user_sgpr_count 2
  .amdhsa_user_sgpr_kernarg_segment_ptr 1
  .amdhsa_system_sgpr_workgroup_id_x 1
.end_amdhsa_kernel
```
